```python
import torch

def _softmax(x, axis=-1):
    return torch.softmax(x, dim=axis)
def _gelu(x):
    return torch.nn.functional.gelu(x, approximate="tanh")
def _silu(x):
    return torch.nn.functional.silu(x)
def _sigmoid(x):
    return torch.sigmoid(x)
def _layernorm(x, axis=-1, eps=1e-5):
    m = x.mean(dim=axis, keepdim=True)
    v = x.var(dim=axis, keepdim=True, unbiased=False)
    return (x - m) / torch.sqrt(v + eps)
def _scatter_add(tgt, idx, src, axis=0):
    return tgt.clone().index_add_(axis, idx, src)
def _segment_sum(src, seg, n):
    out = torch.zeros((n,) + src.shape[1:], dtype=src.dtype)
    return out.index_add_(0, seg, src)
def _pad(x, pw):
    flat = tuple(v for pair in reversed(pw) for v in pair)
    return torch.nn.functional.pad(x, flat)

kernel_name = 'gated_mix__ssm_conv_h3__glu_gated_bilinear__prompt'

def setup_inputs():

    _w = (lambda a: (lambda t: t.to(torch.bfloat16) if t.is_floating_point() else t)(torch.as_tensor(a)))
    def _A_setup():
        B, S, D = 1, 2048, 512
        ks = 4
        return {
            "q": _w((lambda *s: torch.randn(*s, dtype=torch.bfloat16) * 0.05)(B, S, D)),
            "k": _w((lambda *s: torch.randn(*s, dtype=torch.bfloat16) * 0.05)(B, S, D)),
            "v": _w((lambda *s: torch.randn(*s, dtype=torch.bfloat16) * 0.05)(B, S, D)),
            "shift_k": _w((lambda *s: torch.randn(*s, dtype=torch.bfloat16) * 0.05)(D, ks) * 0.5),
            "ssm_k": _w((lambda *s: torch.randn(*s, dtype=torch.bfloat16) * 0.05)(D, S) * (1.0 / S ** 0.5)),
            "ssm_D": _w((lambda *s: torch.randn(*s, dtype=torch.bfloat16) * 0.05)(D)),
        }
    _A_in = _A_setup()

    def _B_setup():
        B, S, D, F = 1, 2048, 512, 1792
        return {
            "x": _w((lambda *s: torch.randn(*s, dtype=torch.bfloat16) * 0.05)(B, S, D)),
            "w_gate": _w((lambda *s: torch.randn(*s, dtype=torch.bfloat16) * 0.1)(D, F) * (D ** -0.5)),
            "w_up": _w((lambda *s: torch.randn(*s, dtype=torch.bfloat16) * 0.1)(D, F) * (D ** -0.5)),
            "w_down": _w((lambda *s: torch.randn(*s, dtype=torch.bfloat16) * 0.1)(F, D) * (F ** -0.5)),
        }
    _B_in = _B_setup()

    return {
        "A_q": _A_in["q"],
        "A_k": _A_in["k"],
        "A_v": _A_in["v"],
        "A_shift_k": _A_in["shift_k"],
        "A_ssm_k": _A_in["ssm_k"],
        "A_ssm_D": _A_in["ssm_D"],
        "B_x": _B_in["x"],
        "B_w_gate": _B_in["w_gate"],
        "B_w_up": _B_in["w_up"],
        "B_w_down": _B_in["w_down"],
        "gate_w": _w((lambda *s: torch.randn(*s, dtype=torch.bfloat16) * 0.05)(512) * 16.0),
    }

def reference(A_q, A_k, A_v, A_shift_k, A_ssm_k, A_ssm_D, B_x, B_w_gate, B_w_up, B_w_down, gate_w):
    def _A_ref(q, k, v, shift_k, ssm_k, ssm_D):
        B, S, D = q.shape
        ks = shift_k.shape[-1]
        k_pad = _pad(k, ((0, 0), (ks - 1, 0), (0, 0)))
        k_shift = torch.zeros_like(k)
        for t in range(ks):
            k_shift = k_shift + k_pad[:, t:t + S, :] * shift_k[:, ks - 1 - t][None, None, :]
        kv = k_shift * v
        L = 2 * S
        kv_pad = _pad(kv, ((0, 0), (0, S), (0, 0)))
        kf_pad = _pad(ssm_k, ((0, 0), (0, S)))
        kv_f = (lambda x, axes=(-2,-1): torch.fft.rfft2(x.float(), dim=axes))(kv_pad[:, None, :, :], axes=(1, 2))
        kf_f = (lambda x, axes=(-2,-1): torch.fft.rfft2(x.float(), dim=axes))(kf_pad[:, None, :], axes=(1, 2))
        kf_f = (lambda x, *d: x.permute(*d))(kf_f, 1, 2, 0)
        y_f = kv_f * kf_f[None, :, :, :]
        y = (lambda x, s, axes=(-2,-1): torch.fft.irfft2(x, s=s, dim=axes).to(torch.bfloat16))(y_f, (1, L), axes=(1, 2))[:, 0, :S, :]
        y = y + kv * ssm_D[None, None, :]
        return q * y

    def _B_ref(x, w_gate, w_up, w_down):
        g = torch.einsum("bsd,df->bsf", x, w_gate)
        u = torch.einsum("bsd,df->bsf", x, w_up)
        h = g * u
        return torch.einsum("bsf,fd->bsd", h, w_down)

    x = A_q
    g = _sigmoid((x * gate_w).sum(-1, keepdims=True))
    a = _A_ref(x, A_k, A_v, A_shift_k, A_ssm_k, A_ssm_D)
    b = _B_ref(x, B_w_gate, B_w_up, B_w_down)
    return g * a + (1 - g) * b
```

```asm
; @launch grid=(256,1,1) block=(512,1,1) lds=163840
.amdgcn_target "amdgcn-amd-amdhsa--gfx950"
.text
.globl gated_mix__ssm_conv_h3__glu_gated_bilinear__prompt_kernel
.p2align 8
.type gated_mix__ssm_conv_h3__glu_gated_bilinear__prompt_kernel,@function
gated_mix__ssm_conv_h3__glu_gated_bilinear__prompt_kernel:
    s_cmp_ge_u32 s2, 256
    s_cbranch_scc1 L_END
    s_load_dwordx8 s[4:11], s[0:1], 0
    s_load_dwordx8 s[24:31], s[0:1], 56
    s_load_dwordx4 s[12:15], s[0:1], 32
    s_load_dwordx4 s[60:63], s[0:1], 88
    s_load_dwordx2 s[18:19], s[0:1], 104
    s_lshr_b32 s22, s2, 3
    s_getpc_b64 s[50:51]
L_PC0:
    s_lshl_b32 s48, s22, 10
    v_lshl_add_u32 v2, v0, 7, s48
    v_min_u32 v2, L_LAST-L_PC0, v2
    v_cmp_gt_u32 vcc, 8, v0
    s_nop 0
    s_and_saveexec_b64 s[52:53], vcc
    s_cbranch_execz L_NOCT
    global_load_dword v250, v2, s[50:51]
L_NOCT:
    s_mov_b64 exec, s[52:53]
    v_lshrrev_b32 v1, 6, v0
    v_and_b32 v0, 63, v0
    v_readfirstlane_b32 s20, v1
    s_and_b32 s21, s2, 7
    s_lshr_b32 s16, s21, 1
    s_lshl_b32 s16, s16, 2
    s_and_b32 s48, s22, 3
    s_add_u32 s16, s16, s48
    s_and_b32 s3, s21, 1
    s_mul_i32 s17, s3, 7
    s_lshr_b32 s48, s22, 2
    s_add_u32 s17, s17, s48
    s_sub_u32 s17, s17, 1
    s_lshl_b32 s59, s21, 5
    s_add_u32 s59, s59, s22
    s_and_b32 s23, s20, 3
    s_cmp_lt_u32 s20, 4
    s_cbranch_scc1 L_COMPUTE
    s_cmp_lt_u32 s22, 4
    s_cbranch_scc1 L_SPARE
    s_setprio 2
    v_lshrrev_b32 v10, 3, v0
    v_lshlrev_b32 v10, 10, v10
    v_and_b32 v11, 7, v0
    v_lshrrev_b32 v12, 4, v0
    v_xor_b32 v11, v11, v12
    v_lshl_add_u32 v10, v11, 4, v10
    s_lshl_b32 s49, s3, 1
    s_xor_b32 s49, s49, s23
    s_xor_b32 s49, s49, 2
    s_lshl_b32 s49, s49, 15
    v_add_u32 v2, s49, v10
    v_xor_b32 v10, 64, v2
    v_add_u32 v3, 7168, v10
    v_add_u32 v4, 14336, v2
    v_add_u32 v5, 21504, v10
    v_mul_u32_u24 v10, 3584, v12
    v_and_b32 v11, 15, v0
    v_lshlrev_b32 v13, 2, v12
    v_xor_b32 v11, v11, v13
    v_lshl_add_u32 v10, v11, 4, v10
    s_mul_i32 s49, s23, 57344
    v_add_u32 v6, s49, v10
    v_add_u32 v7, 13312, v6
    v_xor_b32 v10, 32, v10
    v_add_u32 v10, s49, v10
    v_add_u32 v8, 26624, v10
    v_add_u32 v9, 39936, v10
    s_lshl_b32 s50, s16, 17
    s_lshl_b32 s51, s17, 8
    s_sub_u32 s53, 1835008, s51
    s_waitcnt lgkmcnt(0)
    s_add_u32 s32, s4, s50
    s_addc_u32 s33, s5, 0
    s_mov_b32 s34, 131072
    s_mov_b32 s35, 0x00020000
    s_add_u32 s36, s24, s51
    s_addc_u32 s37, s25, 0
    s_mov_b32 s38, s53
    s_mov_b32 s39, 0x00020000
    s_add_u32 s40, s26, s51
    s_addc_u32 s41, s27, 0
    s_mov_b32 s42, s53
    s_mov_b32 s43, 0x00020000
    v_lshrrev_b32 v16, 3, v0
    v_lshlrev_b32 v16, 10, v16
    v_and_b32 v17, 7, v0
    v_lshl_add_u32 v16, v17, 4, v16
    v_add_u32 v17, 7168, v16
    s_lshl_b32 s50, s22, 16
    s_lshl_b32 s51, s21, 7
    s_add_u32 s50, s50, s51
    s_cmp_eq_u32 s23, 1
    s_cbranch_scc1 L_KD1
    s_mov_b32 s44, s6
    s_mov_b32 s45, s7
    s_mov_b32 s46, 2097152
    s_mov_b32 s47, 0x00020000
    s_cmp_lg_u32 s23, 0
    s_cbranch_scc1 L_KD2
    s_sub_u32 s51, s50, 8192
    v_add_u32 v18, s51, v16
    v_cmp_gt_u32 vcc, 40, v0
    s_nop 1
    v_cndmask_b32 v18, v18, -1, vcc
    s_mov_b32 m0, 114688
    s_nop 0
    buffer_load_dwordx4 v18, s[44:47], 0 offen lds
    s_branch L_KD2
L_KD1:
    s_lshl_b32 s51, s21, 9
    s_add_u32 s44, s10, s51
    s_addc_u32 s45, s11, 0
    s_mov_b32 s46, 512
    s_mov_b32 s47, 0x00020000
    v_lshlrev_b32 v18, 4, v0
    s_mov_b32 m0, 132096
    s_nop 0
    buffer_load_dwordx4 v18, s[44:47], 0 offen lds
    s_mov_b32 s44, s6
    s_mov_b32 s45, s7
    s_mov_b32 s46, 2097152
    s_mov_b32 s47, 0x00020000
L_KD2:
    s_mov_b32 s52, s8
    s_mov_b32 s53, s9
    s_mov_b32 s54, 2097152
    s_mov_b32 s55, 0x00020000
    s_lshl_b32 s51, s23, 14
    s_add_u32 s50, s50, s51
    s_lshl_b32 s51, s23, 11
    s_add_u32 m0, s51, 115712
    s_nop 0
    buffer_load_dwordx4 v16, s[44:47], s50 offen lds
    buffer_load_dwordx4 v17, s[44:47], s50 offen offset:1024 lds
    s_add_u32 m0, s51, 123904
    s_nop 0
    buffer_load_dwordx4 v16, s[52:55], s50 offen lds
    buffer_load_dwordx4 v17, s[52:55], s50 offen offset:1024 lds
    s_mov_b32 s49, 0
    s_lshl_b32 s48, s23, 12
    s_add_u32 m0, s48, 49152
    s_nop 0
    buffer_load_dwordx4 v2, s[32:35], s49 offen offset:0 lds
    buffer_load_dwordx4 v3, s[32:35], s49 offen offset:1024 lds
    buffer_load_dwordx4 v4, s[32:35], s49 offen offset:2048 lds
    buffer_load_dwordx4 v5, s[32:35], s49 offen offset:3072 lds
    s_mov_b32 s49, 0
    s_lshl_b32 s48, s23, 12
    s_add_u32 m0, s48, 65536
    s_nop 0
    buffer_load_dwordx4 v6, s[36:39], s49 offen offset:0 lds
    buffer_load_dwordx4 v7, s[36:39], s49 offen offset:1024 lds
    buffer_load_dwordx4 v8, s[36:39], s49 offen offset:2048 lds
    buffer_load_dwordx4 v9, s[36:39], s49 offen offset:3072 lds
    s_lshl_b32 s48, s23, 11
    s_add_u32 s48, s48, 98304
    v_lshl_add_u32 v40, v0, 4, s48
    s_lshl_b32 s48, s21, 18
    s_lshl_b32 s49, s23, 16
    s_add_u32 s48, s48, s49
    s_lshl_b32 s49, s22, 7
    s_sub_u32 s48, s48, s49
    s_add_u32 s48, s48, 8392576
    v_and_b32 v41, 7, v0
    v_lshrrev_b32 v42, 4, v0
    v_xor_b32 v41, v41, v42
    v_xor_b32 v41, 7, v41
    v_lshlrev_b32 v41, 4, v41
    v_lshrrev_b32 v42, 3, v0
    v_lshl_add_u32 v41, v42, 12, v41
    v_add_u32 v41, s48, v41
    v_xor_b32 v42, 64, v41
    v_add_u32 v42, 32768, v42
    s_lshr_b32 s52, s23, 1
    s_and_b32 s53, s23, 1
    s_lshl_b32 s54, s59, 1
    s_add_u32 s54, s54, s52
    s_lshl_b32 s54, s54, 12
    s_mul_i32 s55, s52, 21248
    s_add_u32 s55, s55, 114688
    s_mul_i32 s58, s53, 8320
    s_add_u32 s58, s58, s55
    s_lshl_b32 s48, s53, 11
    v_lshl_add_u32 v64, v0, 4, s48
    v_subrev_u32 v65, 8, v64
    v_add_u32 v66, 1016, v64
    s_add_u32 s48, s54, 8388608
    v_add_u32 v67, s48, v64
    s_add_u32 s48, s55, 32
    v_add_u32 v78, s48, v64
    s_add_u32 s48, s54, 10485760
    v_add_u32 v225, s48, v64
    v_lshrrev_b32 v76, 1, v0
    v_mul_u32_u24 v76, 4160, v76
    v_and_b32 v77, 1, v0
    v_lshl_add_u32 v76, v77, 4, v76
    v_subrev_u32 v77, 8, v0
    v_and_b32 v77, 31, v77
    v_lshlrev_b32 v77, 4, v77
    v_add_u32 v77, 20736, v77
    v_cmp_gt_u32 vcc, 8, v0
    s_nop 1
    v_cndmask_b32 v76, v77, v76, vcc
    v_add_u32 v76, s55, v76
    v_mov_b32 v32, 0
    v_mov_b32 v33, 0
    v_mov_b32 v34, 0
    v_mov_b32 v35, 0
    v_min_u32 v79, 3, v0
    v_lshlrev_b32 v79, 4, v79
    v_add_u32 v79, 157184, v79
    v_not_b32 v56, v0
    v_and_b32 v56, 3, v56
    v_mul_u32_u24 v56, 4160, v56
    v_lshrrev_b32 v57, 4, v0
    v_lshl_add_u32 v56, v57, 4, v56
    v_bfe_u32 v58, v0, 2, 2
    v_lshl_add_u32 v56, v58, 3, v56
    s_lshl_b32 s48, s53, 8
    s_add_u32 s48, s48, s55
    s_add_u32 s49, s48, 8
    v_add_u32 v216, s49, v56
    v_and_b32 v58, 15, v0
    v_lshlrev_b32 v58, 5, v58
    v_lshlrev_b32 v56, 4, v57
    v_sub_u32 v56, v56, v58
    s_add_u32 s49, s48, 17120
    v_add_u32 v217, s49, v56
    v_mov_b32 v220, 157184
    v_mov_b32 v221, 1
    s_lshl_b32 s48, s23, 2
    s_add_u32 s48, s48, 157200
    v_mov_b32 v218, s48
    v_xor_b32 v219, 4, v218
    s_lshl_b32 s48, s55, 1
    s_sub_u32 s48, s48, s58
    s_add_u32 s48, s48, 8320
    v_lshl_add_u32 v222, v0, 4, s48
    v_lshl_add_u32 v223, v0, 4, s58
    s_lshl_b32 s48, s53, 11
    s_sub_u32 s48, s55, s48
    s_add_u32 s48, s48, 19192
    v_lshl_add_u32 v56, v57, 3, v58
    v_sub_u32 v224, s48, v56
    v_add_u32 v226, s58, v56
    s_lshl_b32 s50, s16, 1
    s_add_u32 s50, s50, s3
    s_lshl_b32 s50, s50, 1
    s_add_u32 s50, s50, s52
    s_lshr_b32 s51, s22, 2
    s_lshl_b32 s51, s51, 1
    s_add_u32 s51, s51, s53
    v_and_b32 v56, 31, v0
    v_lshrrev_b32 v57, 5, v0
    v_lshlrev_b32 v58, 6, v56
    v_lshl_add_u32 v58, v57, 3, v58
    v_add_u32 v227, s58, v58
    s_lshl_b32 s48, s50, 7
    s_add_u32 s48, s48, 12582912
    v_lshl_add_u32 v231, v56, 2, s48
    s_lshl_b32 s48, s52, 7
    s_add_u32 s48, s48, 157440
    v_lshl_add_u32 v232, v56, 2, s48
    v_bfe_u32 v58, v0, 2, 2
    v_lshl_add_u32 v58, v57, 2, v58
    v_lshlrev_b32 v58, 6, v58
    v_bfe_u32 v56, v0, 4, 1
    v_lshl_add_u32 v58, v56, 5, v58
    v_and_b32 v56, 3, v0
    v_lshl_add_u32 v58, v56, 3, v58
    v_add_u32 v228, s58, v58
    v_lshrrev_b32 v57, 2, v0
    v_lshlrev_b32 v56, 4, v56
    s_lshl_b32 s48, s51, 17
    s_lshl_b32 s49, s50, 6
    s_add_u32 s48, s48, s49
    s_add_u32 s48, s48, 10485760
    v_lshl_add_u32 v58, v57, 12, v56
    v_add_u32 v229, s48, v58
    v_add_u32 v230, 65536, v229
    s_lshl_b32 s48, s50, 15
    s_lshl_b32 s49, s51, 6
    s_add_u32 s48, s48, s49
    v_lshl_add_u32 v58, v57, 10, v56
    v_add_u32 v59, s48, v58
    v_add_u32 v60, 16384, v59
    s_mul_i32 s48, s52, 8320
    s_lshl_b32 s49, s53, 12
    s_add_u32 s48, s48, s49
    s_add_u32 s48, s48, 114688
    v_lshl_add_u32 v233, v0, 4, s48
    s_lshl_b32 s48, s59, 14
    s_lshl_b32 s49, s23, 12
    s_add_u32 s48, s48, s49
    s_add_u32 s48, s48, 16777216
    v_lshl_add_u32 v234, v0, 4, s48
    v_lshrrev_b32 v12, 3, v0
    v_lshlrev_b32 v12, 10, v12
    v_bfe_u32 v13, v0, 4, 1
    v_lshlrev_b32 v13, 2, v13
    v_and_b32 v14, 7, v0
    v_xor_b32 v13, v13, v14
    v_lshl_add_u32 v12, v13, 4, v12
    v_add_u32 v13, 15360, v12
    v_add_u32 v14, 456704, v12
    v_add_u32 v15, 472064, v12
    s_waitcnt vmcnt(8)
    s_barrier
    s_mov_b32 s49, 0
    s_lshl_b32 s48, s23, 12
    s_add_u32 m0, s48, 81920
    s_nop 0
    buffer_load_dwordx4 v6, s[40:43], s49 offen offset:0 lds
    buffer_load_dwordx4 v7, s[40:43], s49 offen offset:1024 lds
    buffer_load_dwordx4 v8, s[40:43], s49 offen offset:2048 lds
    buffer_load_dwordx4 v9, s[40:43], s49 offen offset:3072 lds
    s_mov_b32 s49, 128
    s_lshl_b32 s48, s23, 12
    s_add_u32 m0, s48, 0
    s_nop 0
    buffer_load_dwordx4 v2, s[32:35], s49 offen offset:0 lds
    buffer_load_dwordx4 v3, s[32:35], s49 offen offset:1024 lds
    buffer_load_dwordx4 v4, s[32:35], s49 offen offset:2048 lds
    buffer_load_dwordx4 v5, s[32:35], s49 offen offset:3072 lds
    s_mov_b32 s49, 229376
    s_lshl_b32 s48, s23, 12
    s_add_u32 m0, s48, 16384
    s_nop 0
    buffer_load_dwordx4 v6, s[36:39], s49 offen offset:0 lds
    buffer_load_dwordx4 v7, s[36:39], s49 offen offset:1024 lds
    buffer_load_dwordx4 v8, s[36:39], s49 offen offset:2048 lds
    buffer_load_dwordx4 v9, s[36:39], s49 offen offset:3072 lds
    s_waitcnt vmcnt(8)
    s_barrier
    ds_read_b128 v[44:47], v40
    ds_read_b128 v[48:51], v40 offset:1024
    s_mov_b32 s49, 229376
    s_lshl_b32 s48, s23, 12
    s_add_u32 m0, s48, 32768
    s_nop 0
    buffer_load_dwordx4 v6, s[40:43], s49 offen offset:0 lds
    buffer_load_dwordx4 v7, s[40:43], s49 offen offset:1024 lds
    buffer_load_dwordx4 v8, s[40:43], s49 offen offset:2048 lds
    buffer_load_dwordx4 v9, s[40:43], s49 offen offset:3072 lds
    s_mov_b32 s49, 256
    s_lshl_b32 s48, s23, 12
    s_add_u32 m0, s48, 114688
    s_nop 0
    buffer_load_dwordx4 v2, s[32:35], s49 offen offset:0 lds
    buffer_load_dwordx4 v3, s[32:35], s49 offen offset:1024 lds
    buffer_load_dwordx4 v4, s[32:35], s49 offen offset:2048 lds
    buffer_load_dwordx4 v5, s[32:35], s49 offen offset:3072 lds
    s_mov_b32 s49, 458752
    s_lshl_b32 s48, s23, 12
    s_add_u32 m0, s48, 131072
    s_nop 0
    buffer_load_dwordx4 v6, s[36:39], s49 offen offset:0 lds
    buffer_load_dwordx4 v7, s[36:39], s49 offen offset:1024 lds
    buffer_load_dwordx4 v8, s[36:39], s49 offen offset:2048 lds
    buffer_load_dwordx4 v9, s[36:39], s49 offen offset:3072 lds
    s_waitcnt lgkmcnt(0)
    global_store_dwordx4 v41, v[44:47], s[18:19] sc1
    global_store_dwordx4 v42, v[48:51], s[18:19] sc1
    s_load_dwordx2 s[56:57], s[62:63], 0
    s_waitcnt vmcnt(10)
    s_barrier
    s_mov_b32 s49, 458752
    s_lshl_b32 s48, s23, 12
    s_add_u32 m0, s48, 147456
    s_nop 0
    buffer_load_dwordx4 v6, s[40:43], s49 offen offset:0 lds
    buffer_load_dwordx4 v7, s[40:43], s49 offen offset:1024 lds
    buffer_load_dwordx4 v8, s[40:43], s49 offen offset:2048 lds
    buffer_load_dwordx4 v9, s[40:43], s49 offen offset:3072 lds
    s_mov_b32 s49, 384
    s_lshl_b32 s48, s23, 12
    s_add_u32 m0, s48, 49152
    s_nop 0
    buffer_load_dwordx4 v2, s[32:35], s49 offen offset:0 lds
    buffer_load_dwordx4 v3, s[32:35], s49 offen offset:1024 lds
    buffer_load_dwordx4 v4, s[32:35], s49 offen offset:2048 lds
    buffer_load_dwordx4 v5, s[32:35], s49 offen offset:3072 lds
    s_mov_b32 s49, 688128
    s_lshl_b32 s48, s23, 12
    s_add_u32 m0, s48, 65536
    s_nop 0
    buffer_load_dwordx4 v6, s[36:39], s49 offen offset:0 lds
    buffer_load_dwordx4 v7, s[36:39], s49 offen offset:1024 lds
    buffer_load_dwordx4 v8, s[36:39], s49 offen offset:2048 lds
    buffer_load_dwordx4 v9, s[36:39], s49 offen offset:3072 lds
    s_waitcnt vmcnt(8)
    s_barrier
    s_mov_b32 s49, 688128
    s_lshl_b32 s48, s23, 12
    s_add_u32 m0, s48, 81920
    s_nop 0
    buffer_load_dwordx4 v6, s[40:43], s49 offen offset:0 lds
    buffer_load_dwordx4 v7, s[40:43], s49 offen offset:1024 lds
    buffer_load_dwordx4 v8, s[40:43], s49 offen offset:2048 lds
    buffer_load_dwordx4 v9, s[40:43], s49 offen offset:3072 lds
    s_mov_b32 s49, 512
    s_lshl_b32 s48, s23, 12
    s_add_u32 m0, s48, 0
    s_nop 0
    buffer_load_dwordx4 v2, s[32:35], s49 offen offset:0 lds
    buffer_load_dwordx4 v3, s[32:35], s49 offen offset:1024 lds
    buffer_load_dwordx4 v4, s[32:35], s49 offen offset:2048 lds
    buffer_load_dwordx4 v5, s[32:35], s49 offen offset:3072 lds
    s_mov_b32 s49, 917504
    s_lshl_b32 s48, s23, 12
    s_add_u32 m0, s48, 16384
    s_nop 0
    buffer_load_dwordx4 v6, s[36:39], s49 offen offset:0 lds
    buffer_load_dwordx4 v7, s[36:39], s49 offen offset:1024 lds
    buffer_load_dwordx4 v8, s[36:39], s49 offen offset:2048 lds
    buffer_load_dwordx4 v9, s[36:39], s49 offen offset:3072 lds
    s_waitcnt lgkmcnt(0)
    s_cmp_lg_u32 s56, 0
    s_cbranch_scc1 L_TAGD4
    s_mov_b32 s49, 0
    v_mov_b32 v54, 0
L_TAG3:
    s_sleep 8
    global_load_dwordx2 v[52:53], v54, s[62:63] sc1
    s_waitcnt vmcnt(0)
    v_readfirstlane_b32 s56, v52
    v_readfirstlane_b32 s57, v53
    s_add_u32 s49, s49, 1
    s_cmp_lt_u32 s49, 200000
    s_cselect_b32 s48, s56, 1
    s_cmp_eq_u32 s48, 0
    s_cbranch_scc1 L_TAG3
    s_nop 4
L_TAGD4:
    s_cmp_lg_u32 s23, 0
    s_cbranch_scc1 L_NOF5
    s_waitcnt vmcnt(8)
    s_lshl_b32 s48, s59, 7
    s_add_u32 s48, s48, 12648448
    v_mov_b32 v54, s48
    v_mov_b32 v52, s56
    v_mov_b32 v53, s57
    s_mov_b64 exec, 1
    global_store_dwordx2 v54, v[52:53], s[18:19] sc1
    s_mov_b64 exec, -1
L_NOF5:
    s_waitcnt vmcnt(8)
    s_barrier
    s_mov_b32 s49, 917504
    s_lshl_b32 s48, s23, 12
    s_add_u32 m0, s48, 32768
    s_nop 0
    buffer_load_dwordx4 v6, s[40:43], s49 offen offset:0 lds
    buffer_load_dwordx4 v7, s[40:43], s49 offen offset:1024 lds
    buffer_load_dwordx4 v8, s[40:43], s49 offen offset:2048 lds
    buffer_load_dwordx4 v9, s[40:43], s49 offen offset:3072 lds
    s_mov_b32 s49, 640
    s_lshl_b32 s48, s23, 12
    s_add_u32 m0, s48, 114688
    s_nop 0
    buffer_load_dwordx4 v2, s[32:35], s49 offen offset:0 lds
    buffer_load_dwordx4 v3, s[32:35], s49 offen offset:1024 lds
    buffer_load_dwordx4 v4, s[32:35], s49 offen offset:2048 lds
    buffer_load_dwordx4 v5, s[32:35], s49 offen offset:3072 lds
    s_mov_b32 s49, 1146880
    s_lshl_b32 s48, s23, 12
    s_add_u32 m0, s48, 131072
    s_nop 0
    buffer_load_dwordx4 v6, s[36:39], s49 offen offset:0 lds
    buffer_load_dwordx4 v7, s[36:39], s49 offen offset:1024 lds
    buffer_load_dwordx4 v8, s[36:39], s49 offen offset:2048 lds
    buffer_load_dwordx4 v9, s[36:39], s49 offen offset:3072 lds
    s_waitcnt vmcnt(8)
    s_barrier
    s_mov_b32 s49, 1146880
    s_lshl_b32 s48, s23, 12
    s_add_u32 m0, s48, 147456
    s_nop 0
    buffer_load_dwordx4 v6, s[40:43], s49 offen offset:0 lds
    buffer_load_dwordx4 v7, s[40:43], s49 offen offset:1024 lds
    buffer_load_dwordx4 v8, s[40:43], s49 offen offset:2048 lds
    buffer_load_dwordx4 v9, s[40:43], s49 offen offset:3072 lds
    s_mov_b32 s49, 768
    s_lshl_b32 s48, s23, 12
    s_add_u32 m0, s48, 49152
    s_nop 0
    buffer_load_dwordx4 v2, s[32:35], s49 offen offset:0 lds
    buffer_load_dwordx4 v3, s[32:35], s49 offen offset:1024 lds
    buffer_load_dwordx4 v4, s[32:35], s49 offen offset:2048 lds
    buffer_load_dwordx4 v5, s[32:35], s49 offen offset:3072 lds
    s_mov_b32 s49, 1376256
    s_lshl_b32 s48, s23, 12
    s_add_u32 m0, s48, 65536
    s_nop 0
    buffer_load_dwordx4 v6, s[36:39], s49 offen offset:0 lds
    buffer_load_dwordx4 v7, s[36:39], s49 offen offset:1024 lds
    buffer_load_dwordx4 v8, s[36:39], s49 offen offset:2048 lds
    buffer_load_dwordx4 v9, s[36:39], s49 offen offset:3072 lds
    s_mov_b32 s49, 1376256
    s_lshl_b32 s48, s23, 12
    s_add_u32 m0, s48, 81920
    s_nop 0
    buffer_load_dwordx4 v6, s[40:43], s49 offen offset:0 lds
    buffer_load_dwordx4 v7, s[40:43], s49 offen offset:1024 lds
    buffer_load_dwordx4 v8, s[40:43], s49 offen offset:2048 lds
    buffer_load_dwordx4 v9, s[40:43], s49 offen offset:3072 lds
    s_waitcnt vmcnt(12)
    s_barrier
    s_lshl_b32 s46, s21, 12
    s_lshl_b32 s49, s23, 10
    s_add_u32 s46, s46, s49
    s_add_u32 s46, s46, 12648448
    s_load_dwordx2 s[0:1], s[18:19], s46 offset:0
    s_load_dwordx2 s[6:7], s[18:19], s46 offset:128
    s_load_dwordx2 s[8:9], s[18:19], s46 offset:256
    s_load_dwordx2 s[10:11], s[18:19], s46 offset:384
    s_load_dwordx2 s[24:25], s[18:19], s46 offset:512
    s_load_dwordx2 s[26:27], s[18:19], s46 offset:640
    s_load_dwordx2 s[30:31], s[18:19], s46 offset:768
    s_load_dwordx2 s[44:45], s[18:19], s46 offset:896
    s_lshl_b32 s48, s59, 2
    s_load_dword s17, s[14:15], s48
    s_mov_b32 s49, 896
    s_lshl_b32 s48, s23, 12
    s_add_u32 m0, s48, 0
    s_nop 0
    buffer_load_dwordx4 v2, s[32:35], s49 offen offset:0 lds
    buffer_load_dwordx4 v3, s[32:35], s49 offen offset:1024 lds
    buffer_load_dwordx4 v4, s[32:35], s49 offen offset:2048 lds
    buffer_load_dwordx4 v5, s[32:35], s49 offen offset:3072 lds
    s_mov_b32 s49, 1605632
    s_lshl_b32 s48, s23, 12
    s_add_u32 m0, s48, 16384
    s_nop 0
    buffer_load_dwordx4 v6, s[36:39], s49 offen offset:0 lds
    buffer_load_dwordx4 v7, s[36:39], s49 offen offset:1024 lds
    buffer_load_dwordx4 v8, s[36:39], s49 offen offset:2048 lds
    buffer_load_dwordx4 v9, s[36:39], s49 offen offset:3072 lds
    s_mov_b32 s49, 1605632
    s_lshl_b32 s48, s23, 12
    s_add_u32 m0, s48, 32768
    s_nop 0
    buffer_load_dwordx4 v6, s[40:43], s49 offen offset:0 lds
    buffer_load_dwordx4 v7, s[40:43], s49 offen offset:1024 lds
    buffer_load_dwordx4 v8, s[40:43], s49 offen offset:2048 lds
    buffer_load_dwordx4 v9, s[40:43], s49 offen offset:3072 lds
    s_add_u32 s40, s12, s54
    s_addc_u32 s41, s13, 0
    s_mov_b32 s42, 4096
    s_mov_b32 s43, 0x00020000
    buffer_load_dwordx2 v[16:17], v65, s[40:43], 0 offen
    buffer_load_dwordx4 v[18:21], v64, s[40:43], 0 offen
    buffer_load_dwordx2 v[24:25], v66, s[40:43], 0 offen
    buffer_load_dwordx4 v[26:29], v64, s[40:43], 0 offen offset:1024
    global_load_dwordx4 v[208:211], v59, s[4:5]
    global_load_dwordx4 v[212:215], v60, s[4:5]
    s_waitcnt vmcnt(18)
    s_waitcnt lgkmcnt(0)
    s_xor_b64 s[50:51], s[0:1], s[56:57]
    s_xor_b64 s[6:7], s[6:7], s[56:57]
    s_or_b64 s[50:51], s[50:51], s[6:7]
    s_xor_b64 s[8:9], s[8:9], s[56:57]
    s_or_b64 s[50:51], s[50:51], s[8:9]
    s_xor_b64 s[10:11], s[10:11], s[56:57]
    s_or_b64 s[50:51], s[50:51], s[10:11]
    s_xor_b64 s[24:25], s[24:25], s[56:57]
    s_or_b64 s[50:51], s[50:51], s[24:25]
    s_xor_b64 s[26:27], s[26:27], s[56:57]
    s_or_b64 s[50:51], s[50:51], s[26:27]
    s_xor_b64 s[30:31], s[30:31], s[56:57]
    s_or_b64 s[50:51], s[50:51], s[30:31]
    s_xor_b64 s[44:45], s[44:45], s[56:57]
    s_or_b64 s[50:51], s[50:51], s[44:45]
    s_cmp_eq_u64 s[50:51], 0
    s_cbranch_scc1 L_SPD6
    v_and_b32 v54, 7, v0
    v_lshl_add_u32 v54, v54, 7, s46
    s_mov_b32 s49, 0
L_POLL7:
    global_load_dwordx2 v[52:53], v54, s[18:19] sc1
    s_waitcnt vmcnt(0)
L_POLC8:
    v_cmp_ne_u64 vcc, s[56:57], v[52:53]
    s_nop 0
    s_cmp_eq_u64 vcc, 0
    s_cbranch_scc1 L_POLD9
    s_sleep 8
    s_add_u32 s49, s49, 1
    s_cmp_lt_u32 s49, 200000
    s_cbranch_scc1 L_POLL7
L_POLD9:
L_SPD6:
    s_barrier
    global_load_dwordx4 v[68:71], v67, s[18:19] sc1
    global_load_dwordx4 v[72:75], v67, s[18:19] offset:1024 sc1
    s_mul_i32 s48, s3, 917504
    s_lshr_b32 s49, s22, 2
    s_lshl_b32 s49, s49, 7
    s_add_u32 s48, s48, s49
    s_sub_u32 s49, 1835008, s48
    s_add_u32 s32, s28, s48
    s_addc_u32 s33, s29, 0
    s_mov_b32 s34, s49
    s_mov_b32 s35, 0x00020000
    s_lshr_b32 s48, s23, 1
    s_lshl_b32 s48, s48, 15
    s_and_b32 s49, s23, 1
    s_lshl_b32 s49, s49, 13
    s_add_u32 s48, s48, s49
    s_add_u32 s49, s48, 0
    s_lshl_b32 s48, s23, 12
    s_add_u32 m0, s48, 98304
    s_nop 0
    buffer_load_dwordx4 v12, s[32:35], s49 offen offset:0 lds
    buffer_load_dwordx4 v13, s[32:35], s49 offen offset:1024 lds
    buffer_load_dwordx4 v14, s[32:35], s49 offen offset:2048 lds
    buffer_load_dwordx4 v15, s[32:35], s49 offen offset:3072 lds
    ds_write_b128 v79, v[32:35]
    s_waitcnt lgkmcnt(0)
    s_waitcnt vmcnt(12)
    s_barrier
    s_setprio 2
    s_waitcnt vmcnt(4)
L_BUILD:
    ds_write_b128 v76, v[32:35]
    v_alignbit_b32 v80, v18, v17, 16
    v_alignbit_b32 v81, v19, v18, 16
    v_alignbit_b32 v82, v20, v19, 16
    v_alignbit_b32 v83, v21, v20, 16
    v_mov_b32 v84, v17
    v_mov_b32 v85, v18
    v_mov_b32 v86, v19
    v_mov_b32 v87, v20
    v_alignbit_b32 v88, v17, v16, 16
    v_alignbit_b32 v89, v18, v17, 16
    v_alignbit_b32 v90, v19, v18, 16
    v_alignbit_b32 v91, v20, v19, 16
    ds_write_b128 v78, v[18:21] offset:0
    ds_write_b128 v78, v[80:83] offset:4160
    ds_write_b128 v78, v[84:87] offset:8320
    ds_write_b128 v78, v[88:91] offset:12480
    v_alignbit_b32 v92, v26, v25, 16
    v_alignbit_b32 v93, v27, v26, 16
    v_alignbit_b32 v94, v28, v27, 16
    v_alignbit_b32 v95, v29, v28, 16
    v_mov_b32 v96, v25
    v_mov_b32 v97, v26
    v_mov_b32 v98, v27
    v_mov_b32 v99, v28
    v_alignbit_b32 v100, v25, v24, 16
    v_alignbit_b32 v101, v26, v25, 16
    v_alignbit_b32 v102, v27, v26, 16
    v_alignbit_b32 v103, v28, v27, 16
    ds_write_b128 v78, v[26:29] offset:1024
    ds_write_b128 v78, v[92:95] offset:5184
    ds_write_b128 v78, v[96:99] offset:9344
    ds_write_b128 v78, v[100:103] offset:13504
    ds_write_b128 v78, v[68:71] offset:16608
    ds_write_b128 v78, v[72:75] offset:17632
    v_mov_b32 v1, 1
    s_waitcnt lgkmcnt(0)
    ds_write_b32 v218, v1
    s_lshl_b32 s50, s17, 16
    s_and_b32 s17, s17, 0xffff0000
    s_cmp_eq_u32 s52, 0
    s_cselect_b32 s17, s50, s17
    s_lshr_b32 s46, s22, 2
    s_lshl_b32 s46, s46, 12
    s_lshl_b32 s50, s23, 10
    s_add_u32 s46, s46, s50
    s_add_u32 s46, s46, 12713984
    s_setprio 0
    s_mov_b32 s49, 0
L_SPIN10:
    ds_read_b32 v1, v220 offset:44
    s_waitcnt lgkmcnt(0)
    v_readfirstlane_b32 s48, v1
    s_nop 0
    s_cmp_ge_u32 s48, 4
    s_cbranch_scc1 L_SPUN11
    s_sleep 1
    s_add_u32 s49, s49, 1
    s_cmp_lt_u32 s49, 3200000
    s_cbranch_scc1 L_SPIN10
L_SPUN11:
    s_setprio 2
    s_lshr_b32 s48, s23, 1
    s_lshl_b32 s48, s48, 15
    s_and_b32 s49, s23, 1
    s_lshl_b32 s49, s49, 13
    s_add_u32 s48, s48, s49
    s_add_u32 s49, s48, 65536
    s_lshl_b32 s48, s23, 12
    s_add_u32 m0, s48, 49152
    s_nop 0
    buffer_load_dwordx4 v12, s[32:35], s49 offen offset:0 lds
    buffer_load_dwordx4 v13, s[32:35], s49 offen offset:1024 lds
    buffer_load_dwordx4 v14, s[32:35], s49 offen offset:2048 lds
    buffer_load_dwordx4 v15, s[32:35], s49 offen offset:3072 lds
    s_lshr_b32 s48, s23, 1
    s_lshl_b32 s48, s48, 15
    s_and_b32 s49, s23, 1
    s_lshl_b32 s49, s49, 13
    s_add_u32 s48, s48, s49
    s_add_u32 s49, s48, 131072
    s_lshl_b32 s48, s23, 12
    s_add_u32 m0, s48, 65536
    s_nop 0
    buffer_load_dwordx4 v12, s[32:35], s49 offen offset:0 lds
    buffer_load_dwordx4 v13, s[32:35], s49 offen offset:1024 lds
    buffer_load_dwordx4 v14, s[32:35], s49 offen offset:2048 lds
    buffer_load_dwordx4 v15, s[32:35], s49 offen offset:3072 lds
    s_lshr_b32 s48, s23, 1
    s_lshl_b32 s48, s48, 15
    s_and_b32 s49, s23, 1
    s_lshl_b32 s49, s49, 13
    s_add_u32 s48, s48, s49
    s_add_u32 s49, s48, 196608
    s_lshl_b32 s48, s23, 12
    s_add_u32 m0, s48, 81920
    s_nop 0
    buffer_load_dwordx4 v12, s[32:35], s49 offen offset:0 lds
    buffer_load_dwordx4 v13, s[32:35], s49 offen offset:1024 lds
    buffer_load_dwordx4 v14, s[32:35], s49 offen offset:2048 lds
    buffer_load_dwordx4 v15, s[32:35], s49 offen offset:3072 lds
    s_setprio 0
    s_mov_b32 s49, 0
L_SPIN12:
    ds_read_b32 v1, v219 offset:0
    s_waitcnt lgkmcnt(0)
    v_readfirstlane_b32 s48, v1
    s_nop 0
    s_cmp_ge_u32 s48, 1
    s_cbranch_scc1 L_SPUN13
    s_sleep 1
    s_add_u32 s49, s49, 1
    s_cmp_lt_u32 s49, 3200000
    s_cbranch_scc1 L_SPIN12
L_SPUN13:
    s_setprio 0
    ds_read_b64 v[80:81], v216 offset:0
    ds_read_b64 v[82:83], v216 offset:8
    ds_read_b128 v[112:115], v217 offset:3584
    ds_read_b64 v[84:85], v216 offset:512
    ds_read_b64 v[86:87], v216 offset:520
    ds_read_b128 v[116:119], v217 offset:3072
    ds_read_b64 v[88:89], v216 offset:1024
    ds_read_b64 v[90:91], v216 offset:1032
    ds_read_b128 v[120:123], v217 offset:2560
    ds_read_b64 v[92:93], v216 offset:1536
    ds_read_b64 v[94:95], v216 offset:1544
    ds_read_b128 v[124:127], v217 offset:2048
    ds_read_b64 v[96:97], v216 offset:2048
    ds_read_b64 v[98:99], v216 offset:2056
    ds_read_b128 v[128:131], v217 offset:1536
    ds_read_b64 v[100:101], v216 offset:2560
    ds_read_b64 v[102:103], v216 offset:2568
    ds_read_b128 v[132:135], v217 offset:1024
    ds_read_b64 v[104:105], v216 offset:3072
    ds_read_b64 v[106:107], v216 offset:3080
    ds_read_b128 v[136:139], v217 offset:512
    ds_read_b64 v[108:109], v216 offset:3584
    ds_read_b64 v[110:111], v216 offset:3592
    ds_read_b128 v[140:143], v217 offset:0
    s_waitcnt lgkmcnt(14)
    v_mfma_f32_16x16x32_bf16 v[48:51], v[80:83], v[112:115], 0
    v_mfma_f32_16x16x32_bf16 v[52:55], v[80:83], v[116:119], 0
    v_mfma_f32_16x16x32_bf16 v[52:55], v[84:87], v[112:115], v[52:55]
    v_mfma_f32_16x16x32_bf16 v[56:59], v[84:87], v[116:119], 0
    v_mfma_f32_16x16x32_bf16 v[56:59], v[80:83], v[120:123], v[56:59]
    v_mfma_f32_16x16x32_bf16 v[60:63], v[84:87], v[120:123], 0
    v_mfma_f32_16x16x32_bf16 v[56:59], v[88:91], v[112:115], v[56:59]
    v_mfma_f32_16x16x32_bf16 v[60:63], v[88:91], v[116:119], v[60:63]
    v_mfma_f32_16x16x32_bf16 v[64:67], v[88:91], v[120:123], 0
    s_waitcnt lgkmcnt(12)
    v_mfma_f32_16x16x32_bf16 v[60:63], v[80:83], v[124:127], v[60:63]
    v_mfma_f32_16x16x32_bf16 v[64:67], v[84:87], v[124:127], v[64:67]
    v_mfma_f32_16x16x32_bf16 v[68:71], v[88:91], v[124:127], 0
    v_mfma_f32_16x16x32_bf16 v[60:63], v[92:95], v[112:115], v[60:63]
    v_mfma_f32_16x16x32_bf16 v[64:67], v[92:95], v[116:119], v[64:67]
    v_mfma_f32_16x16x32_bf16 v[68:71], v[92:95], v[120:123], v[68:71]
    v_mfma_f32_16x16x32_bf16 v[72:75], v[92:95], v[124:127], 0
    s_waitcnt lgkmcnt(9)
    v_mfma_f32_16x16x32_bf16 v[64:67], v[80:83], v[128:131], v[64:67]
    v_mfma_f32_16x16x32_bf16 v[68:71], v[84:87], v[128:131], v[68:71]
    v_mfma_f32_16x16x32_bf16 v[72:75], v[88:91], v[128:131], v[72:75]
    v_mfma_f32_16x16x32_bf16 v[76:79], v[92:95], v[128:131], 0
    v_mfma_f32_16x16x32_bf16 v[64:67], v[96:99], v[112:115], v[64:67]
    v_mfma_f32_16x16x32_bf16 v[68:71], v[96:99], v[116:119], v[68:71]
    v_mfma_f32_16x16x32_bf16 v[72:75], v[96:99], v[120:123], v[72:75]
    v_mfma_f32_16x16x32_bf16 v[76:79], v[96:99], v[124:127], v[76:79]
    s_waitcnt lgkmcnt(6)
    v_mfma_f32_16x16x32_bf16 v[68:71], v[80:83], v[132:135], v[68:71]
    ds_read_b64 v[144:145], v216 offset:64
    v_mfma_f32_16x16x32_bf16 v[72:75], v[84:87], v[132:135], v[72:75]
    ds_read_b64 v[146:147], v216 offset:72
    v_mfma_f32_16x16x32_bf16 v[76:79], v[88:91], v[132:135], v[76:79]
    ds_read_b128 v[176:179], v217 offset:3648
    v_mfma_f32_16x16x32_bf16 v[68:71], v[100:103], v[112:115], v[68:71]
    v_mfma_f32_16x16x32_bf16 v[72:75], v[100:103], v[116:119], v[72:75]
    v_mfma_f32_16x16x32_bf16 v[76:79], v[100:103], v[120:123], v[76:79]
    s_waitcnt lgkmcnt(6)
    v_mfma_f32_16x16x32_bf16 v[72:75], v[80:83], v[136:139], v[72:75]
    ds_read_b64 v[148:149], v216 offset:576
    v_mfma_f32_16x16x32_bf16 v[76:79], v[84:87], v[136:139], v[76:79]
    ds_read_b64 v[150:151], v216 offset:584
    v_mfma_f32_16x16x32_bf16 v[72:75], v[104:107], v[112:115], v[72:75]
    ds_read_b128 v[180:183], v217 offset:3136
    v_mfma_f32_16x16x32_bf16 v[76:79], v[104:107], v[116:119], v[76:79]
    s_waitcnt lgkmcnt(6)
    v_mfma_f32_16x16x32_bf16 v[76:79], v[80:83], v[140:143], v[76:79]
    ds_read_b64 v[152:153], v216 offset:1088
    v_mfma_f32_16x16x32_bf16 v[76:79], v[108:111], v[112:115], v[76:79]
    ds_read_b64 v[154:155], v216 offset:1096
    ds_read_b128 v[184:187], v217 offset:2624
    ds_read_b64 v[156:157], v216 offset:1600
    ds_read_b64 v[158:159], v216 offset:1608
    ds_read_b128 v[188:191], v217 offset:2112
    ds_read_b64 v[160:161], v216 offset:2112
    ds_read_b64 v[162:163], v216 offset:2120
    ds_read_b128 v[192:195], v217 offset:1600
    ds_read_b64 v[164:165], v216 offset:2624
    ds_read_b64 v[166:167], v216 offset:2632
    ds_read_b128 v[196:199], v217 offset:1088
    ds_read_b64 v[168:169], v216 offset:3136
    ds_read_b64 v[170:171], v216 offset:3144
    ds_read_b128 v[200:203], v217 offset:576
    ds_read_b64 v[172:173], v216 offset:3648
    ds_read_b64 v[174:175], v216 offset:3656
    ds_read_b128 v[204:207], v217 offset:64
    s_waitcnt lgkmcnt(14)
    v_mfma_f32_16x16x32_bf16 v[48:51], v[144:147], v[176:179], v[48:51]
    ds_read_b64 v[80:81], v216 offset:128
    v_mfma_f32_16x16x32_bf16 v[52:55], v[144:147], v[180:183], v[52:55]
    ds_read_b64 v[82:83], v216 offset:136
    v_mfma_f32_16x16x32_bf16 v[52:55], v[148:151], v[176:179], v[52:55]
    ds_read_b128 v[112:115], v217 offset:3712
    v_mfma_f32_16x16x32_bf16 v[56:59], v[148:151], v[180:183], v[56:59]
    ds_read_b64 v[84:85], v216 offset:640
    v_mfma_f32_16x16x32_bf16 v[56:59], v[144:147], v[184:187], v[56:59]
    ds_read_b64 v[86:87], v216 offset:648
    v_mfma_f32_16x16x32_bf16 v[60:63], v[148:151], v[184:187], v[60:63]
    ds_read_b128 v[116:119], v217 offset:3200
    v_mfma_f32_16x16x32_bf16 v[56:59], v[152:155], v[176:179], v[56:59]
    ds_read_b64 v[88:89], v216 offset:1152
    v_mfma_f32_16x16x32_bf16 v[60:63], v[152:155], v[180:183], v[60:63]
    ds_read_b64 v[90:91], v216 offset:1160
    v_mfma_f32_16x16x32_bf16 v[64:67], v[152:155], v[184:187], v[64:67]
    ds_read_b128 v[120:123], v217 offset:2688
    s_waitcnt lgkmcnt(14)
    v_mfma_f32_16x16x32_bf16 v[60:63], v[144:147], v[188:191], v[60:63]
    ds_read_b64 v[92:93], v216 offset:1664
    v_mfma_f32_16x16x32_bf16 v[64:67], v[148:151], v[188:191], v[64:67]
    ds_read_b64 v[94:95], v216 offset:1672
    v_mfma_f32_16x16x32_bf16 v[68:71], v[152:155], v[188:191], v[68:71]
    ds_read_b128 v[124:127], v217 offset:2176
    v_mfma_f32_16x16x32_bf16 v[60:63], v[156:159], v[176:179], v[60:63]
    ds_read_b64 v[96:97], v216 offset:2176
    v_mfma_f32_16x16x32_bf16 v[64:67], v[156:159], v[180:183], v[64:67]
    ds_read_b64 v[98:99], v216 offset:2184
    v_mfma_f32_16x16x32_bf16 v[68:71], v[156:159], v[184:187], v[68:71]
    ds_read_b128 v[128:131], v217 offset:1664
    v_mfma_f32_16x16x32_bf16 v[72:75], v[156:159], v[188:191], v[72:75]
    ds_read_b64 v[100:101], v216 offset:2688
    v_mfma_f32_16x16x32_bf16 v[64:67], v[144:147], v[192:195], v[64:67]
    ds_read_b64 v[102:103], v216 offset:2696
    v_mfma_f32_16x16x32_bf16 v[68:71], v[148:151], v[192:195], v[68:71]
    ds_read_b128 v[132:135], v217 offset:1152
    v_mfma_f32_16x16x32_bf16 v[72:75], v[152:155], v[192:195], v[72:75]
    ds_read_b64 v[104:105], v216 offset:3200
    v_mfma_f32_16x16x32_bf16 v[76:79], v[156:159], v[192:195], v[76:79]
    ds_read_b64 v[106:107], v216 offset:3208
    v_mfma_f32_16x16x32_bf16 v[64:67], v[160:163], v[176:179], v[64:67]
    ds_read_b128 v[136:139], v217 offset:640
    v_mfma_f32_16x16x32_bf16 v[68:71], v[160:163], v[180:183], v[68:71]
    ds_read_b64 v[108:109], v216 offset:3712
    v_mfma_f32_16x16x32_bf16 v[72:75], v[160:163], v[184:187], v[72:75]
    ds_read_b64 v[110:111], v216 offset:3720
    v_mfma_f32_16x16x32_bf16 v[76:79], v[160:163], v[188:191], v[76:79]
    ds_read_b128 v[140:143], v217 offset:128
    v_mfma_f32_16x16x32_bf16 v[68:71], v[144:147], v[196:199], v[68:71]
    v_mfma_f32_16x16x32_bf16 v[72:75], v[148:151], v[196:199], v[72:75]
    v_mfma_f32_16x16x32_bf16 v[76:79], v[152:155], v[196:199], v[76:79]
    v_mfma_f32_16x16x32_bf16 v[68:71], v[164:167], v[176:179], v[68:71]
    v_mfma_f32_16x16x32_bf16 v[72:75], v[164:167], v[180:183], v[72:75]
    v_mfma_f32_16x16x32_bf16 v[76:79], v[164:167], v[184:187], v[76:79]
    s_waitcnt lgkmcnt(14)
    v_mfma_f32_16x16x32_bf16 v[72:75], v[144:147], v[200:203], v[72:75]
    v_mfma_f32_16x16x32_bf16 v[76:79], v[148:151], v[200:203], v[76:79]
    v_mfma_f32_16x16x32_bf16 v[72:75], v[168:171], v[176:179], v[72:75]
    v_mfma_f32_16x16x32_bf16 v[76:79], v[168:171], v[180:183], v[76:79]
    v_mfma_f32_16x16x32_bf16 v[76:79], v[144:147], v[204:207], v[76:79]
    v_mfma_f32_16x16x32_bf16 v[76:79], v[172:175], v[176:179], v[76:79]
    s_waitcnt vmcnt(0)
    s_mov_b64 exec, 1
    ds_add_u32 v220, v221 offset:8
    s_mov_b64 exec, -1
    v_mfma_f32_16x16x32_bf16 v[48:51], v[80:83], v[112:115], v[48:51]
    ds_read_b64 v[144:145], v216 offset:192
    v_mfma_f32_16x16x32_bf16 v[52:55], v[80:83], v[116:119], v[52:55]
    ds_read_b64 v[146:147], v216 offset:200
    v_mfma_f32_16x16x32_bf16 v[52:55], v[84:87], v[112:115], v[52:55]
    ds_read_b128 v[176:179], v217 offset:3776
    v_mfma_f32_16x16x32_bf16 v[56:59], v[84:87], v[116:119], v[56:59]
    ds_read_b64 v[148:149], v216 offset:704
    v_mfma_f32_16x16x32_bf16 v[56:59], v[80:83], v[120:123], v[56:59]
    ds_read_b64 v[150:151], v216 offset:712
    v_mfma_f32_16x16x32_bf16 v[60:63], v[84:87], v[120:123], v[60:63]
    ds_read_b128 v[180:183], v217 offset:3264
    v_mfma_f32_16x16x32_bf16 v[56:59], v[88:91], v[112:115], v[56:59]
    ds_read_b64 v[152:153], v216 offset:1216
    v_mfma_f32_16x16x32_bf16 v[60:63], v[88:91], v[116:119], v[60:63]
    ds_read_b64 v[154:155], v216 offset:1224
    v_mfma_f32_16x16x32_bf16 v[64:67], v[88:91], v[120:123], v[64:67]
    ds_read_b128 v[184:187], v217 offset:2752
    s_waitcnt lgkmcnt(14)
    v_mfma_f32_16x16x32_bf16 v[60:63], v[80:83], v[124:127], v[60:63]
    ds_read_b64 v[156:157], v216 offset:1728
    v_mfma_f32_16x16x32_bf16 v[64:67], v[84:87], v[124:127], v[64:67]
    ds_read_b64 v[158:159], v216 offset:1736
    v_mfma_f32_16x16x32_bf16 v[68:71], v[88:91], v[124:127], v[68:71]
    ds_read_b128 v[188:191], v217 offset:2240
    v_mfma_f32_16x16x32_bf16 v[60:63], v[92:95], v[112:115], v[60:63]
    ds_read_b64 v[160:161], v216 offset:2240
    v_mfma_f32_16x16x32_bf16 v[64:67], v[92:95], v[116:119], v[64:67]
    ds_read_b64 v[162:163], v216 offset:2248
    v_mfma_f32_16x16x32_bf16 v[68:71], v[92:95], v[120:123], v[68:71]
    ds_read_b128 v[192:195], v217 offset:1728
    v_mfma_f32_16x16x32_bf16 v[72:75], v[92:95], v[124:127], v[72:75]
    ds_read_b64 v[164:165], v216 offset:2752
    v_mfma_f32_16x16x32_bf16 v[64:67], v[80:83], v[128:131], v[64:67]
    ds_read_b64 v[166:167], v216 offset:2760
    v_mfma_f32_16x16x32_bf16 v[68:71], v[84:87], v[128:131], v[68:71]
    ds_read_b128 v[196:199], v217 offset:1216
    v_mfma_f32_16x16x32_bf16 v[72:75], v[88:91], v[128:131], v[72:75]
    ds_read_b64 v[168:169], v216 offset:3264
    v_mfma_f32_16x16x32_bf16 v[76:79], v[92:95], v[128:131], v[76:79]
    ds_read_b64 v[170:171], v216 offset:3272
    v_mfma_f32_16x16x32_bf16 v[64:67], v[96:99], v[112:115], v[64:67]
    ds_read_b128 v[200:203], v217 offset:704
    v_mfma_f32_16x16x32_bf16 v[68:71], v[96:99], v[116:119], v[68:71]
    ds_read_b64 v[172:173], v216 offset:3776
    v_mfma_f32_16x16x32_bf16 v[72:75], v[96:99], v[120:123], v[72:75]
    ds_read_b64 v[174:175], v216 offset:3784
    v_mfma_f32_16x16x32_bf16 v[76:79], v[96:99], v[124:127], v[76:79]
    ds_read_b128 v[204:207], v217 offset:192
    v_mfma_f32_16x16x32_bf16 v[68:71], v[80:83], v[132:135], v[68:71]
    v_mfma_f32_16x16x32_bf16 v[72:75], v[84:87], v[132:135], v[72:75]
    v_mfma_f32_16x16x32_bf16 v[76:79], v[88:91], v[132:135], v[76:79]
    v_mfma_f32_16x16x32_bf16 v[68:71], v[100:103], v[112:115], v[68:71]
    v_mfma_f32_16x16x32_bf16 v[72:75], v[100:103], v[116:119], v[72:75]
    v_mfma_f32_16x16x32_bf16 v[76:79], v[100:103], v[120:123], v[76:79]
    s_waitcnt lgkmcnt(14)
    v_mfma_f32_16x16x32_bf16 v[72:75], v[80:83], v[136:139], v[72:75]
    v_mfma_f32_16x16x32_bf16 v[76:79], v[84:87], v[136:139], v[76:79]
    v_mfma_f32_16x16x32_bf16 v[72:75], v[104:107], v[112:115], v[72:75]
    v_mfma_f32_16x16x32_bf16 v[76:79], v[104:107], v[116:119], v[76:79]
    v_mfma_f32_16x16x32_bf16 v[76:79], v[80:83], v[140:143], v[76:79]
    v_mfma_f32_16x16x32_bf16 v[76:79], v[108:111], v[112:115], v[76:79]
    v_mfma_f32_16x16x32_bf16 v[48:51], v[144:147], v[176:179], v[48:51]
    ds_read_b64 v[112:113], v224 offset:1536
    v_mfma_f32_16x16x32_bf16 v[52:55], v[144:147], v[180:183], v[52:55]
    ds_read_b64 v[114:115], v224 offset:1024
    v_mfma_f32_16x16x32_bf16 v[52:55], v[148:151], v[176:179], v[52:55]
    ds_read_b64 v[116:117], v224 offset:512
    v_mfma_f32_16x16x32_bf16 v[56:59], v[148:151], v[180:183], v[56:59]
    ds_read_b64 v[118:119], v224 offset:0
    v_mfma_f32_16x16x32_bf16 v[56:59], v[144:147], v[184:187], v[56:59]
    v_mfma_f32_16x16x32_bf16 v[60:63], v[148:151], v[184:187], v[60:63]
    v_mfma_f32_16x16x32_bf16 v[56:59], v[152:155], v[176:179], v[56:59]
    v_mfma_f32_16x16x32_bf16 v[60:63], v[152:155], v[180:183], v[60:63]
    v_mfma_f32_16x16x32_bf16 v[64:67], v[152:155], v[184:187], v[64:67]
    v_mov_b32 v1, 2
    s_waitcnt lgkmcnt(0)
    ds_write_b32 v218, v1
    v_mfma_f32_16x16x32_bf16 v[60:63], v[144:147], v[188:191], v[60:63]
    v_mfma_f32_16x16x32_bf16 v[64:67], v[148:151], v[188:191], v[64:67]
    v_mfma_f32_16x16x32_bf16 v[68:71], v[152:155], v[188:191], v[68:71]
    v_mfma_f32_16x16x32_bf16 v[60:63], v[156:159], v[176:179], v[60:63]
    v_mfma_f32_16x16x32_bf16 v[64:67], v[156:159], v[180:183], v[64:67]
    v_mfma_f32_16x16x32_bf16 v[68:71], v[156:159], v[184:187], v[68:71]
    v_mfma_f32_16x16x32_bf16 v[72:75], v[156:159], v[188:191], v[72:75]
    v_mfma_f32_16x16x32_bf16 v[64:67], v[144:147], v[192:195], v[64:67]
    v_mfma_f32_16x16x32_bf16 v[68:71], v[148:151], v[192:195], v[68:71]
    v_mfma_f32_16x16x32_bf16 v[72:75], v[152:155], v[192:195], v[72:75]
    v_mfma_f32_16x16x32_bf16 v[76:79], v[156:159], v[192:195], v[76:79]
    v_mfma_f32_16x16x32_bf16 v[64:67], v[160:163], v[176:179], v[64:67]
    v_mfma_f32_16x16x32_bf16 v[68:71], v[160:163], v[180:183], v[68:71]
    v_mfma_f32_16x16x32_bf16 v[72:75], v[160:163], v[184:187], v[72:75]
    v_mfma_f32_16x16x32_bf16 v[76:79], v[160:163], v[188:191], v[76:79]
    v_mfma_f32_16x16x32_bf16 v[68:71], v[144:147], v[196:199], v[68:71]
    v_mfma_f32_16x16x32_bf16 v[72:75], v[148:151], v[196:199], v[72:75]
    v_mfma_f32_16x16x32_bf16 v[76:79], v[152:155], v[196:199], v[76:79]
    v_mfma_f32_16x16x32_bf16 v[68:71], v[164:167], v[176:179], v[68:71]
    v_mfma_f32_16x16x32_bf16 v[72:75], v[164:167], v[180:183], v[72:75]
    v_mfma_f32_16x16x32_bf16 v[76:79], v[164:167], v[184:187], v[76:79]
    v_mfma_f32_16x16x32_bf16 v[72:75], v[144:147], v[200:203], v[72:75]
    v_mfma_f32_16x16x32_bf16 v[76:79], v[148:151], v[200:203], v[76:79]
    v_mfma_f32_16x16x32_bf16 v[72:75], v[168:171], v[176:179], v[72:75]
    v_mfma_f32_16x16x32_bf16 v[76:79], v[168:171], v[180:183], v[76:79]
    v_mfma_f32_16x16x32_bf16 v[76:79], v[144:147], v[204:207], v[76:79]
    v_mfma_f32_16x16x32_bf16 v[76:79], v[172:175], v[176:179], v[76:79]
    s_setprio 2
    s_mov_b32 s49, 0
L_SPIN14:
    ds_read_b32 v1, v219 offset:0
    s_waitcnt lgkmcnt(0)
    v_readfirstlane_b32 s48, v1
    s_nop 0
    s_cmp_ge_u32 s48, 2
    s_cbranch_scc1 L_SPUN15
    s_sleep 1
    s_add_u32 s49, s49, 1
    s_cmp_lt_u32 s49, 3200000
    s_cbranch_scc1 L_SPIN14
L_SPUN15:
    s_cmp_eq_u32 s53, 0
    s_cbranch_scc1 L_SEND_HI
    ds_write_b128 v222, v[48:51] offset:0
    ds_write_b128 v222, v[52:55] offset:1024
    ds_write_b128 v222, v[56:59] offset:2048
    ds_write_b128 v222, v[60:63] offset:3072
    v_mov_b32 v1, 3
    s_waitcnt lgkmcnt(0)
    ds_write_b32 v218, v1
    v_mov_b32 v48, v64
    v_mov_b32 v49, v65
    v_mov_b32 v50, v66
    v_mov_b32 v51, v67
    v_mov_b32 v52, v68
    v_mov_b32 v53, v69
    v_mov_b32 v54, v70
    v_mov_b32 v55, v71
    v_mov_b32 v56, v72
    v_mov_b32 v57, v73
    v_mov_b32 v58, v74
    v_mov_b32 v59, v75
    v_mov_b32 v60, v76
    v_mov_b32 v61, v77
    v_mov_b32 v62, v78
    v_mov_b32 v63, v79
    s_branch L_SENT
L_SEND_HI:
    ds_write_b128 v222, v[64:67] offset:0
    ds_write_b128 v222, v[68:71] offset:1024
    ds_write_b128 v222, v[72:75] offset:2048
    ds_write_b128 v222, v[76:79] offset:3072
    v_mov_b32 v1, 3
    s_waitcnt lgkmcnt(0)
    ds_write_b32 v218, v1
L_SENT:
    v_and_b32 v120, 0xffff0000, v113
    v_lshlrev_b32 v121, 16, v113
    v_and_b32 v122, 0xffff0000, v112
    v_lshlrev_b32 v123, 16, v112
    v_fmac_f32 v48, s17, v120
    v_fmac_f32 v49, s17, v121
    v_fmac_f32 v50, s17, v122
    v_fmac_f32 v51, s17, v123
    v_and_b32 v120, 0xffff0000, v115
    v_lshlrev_b32 v121, 16, v115
    v_and_b32 v122, 0xffff0000, v114
    v_lshlrev_b32 v123, 16, v114
    v_fmac_f32 v52, s17, v120
    v_fmac_f32 v53, s17, v121
    v_fmac_f32 v54, s17, v122
    v_fmac_f32 v55, s17, v123
    v_and_b32 v120, 0xffff0000, v117
    v_lshlrev_b32 v121, 16, v117
    v_and_b32 v122, 0xffff0000, v116
    v_lshlrev_b32 v123, 16, v116
    v_fmac_f32 v56, s17, v120
    v_fmac_f32 v57, s17, v121
    v_fmac_f32 v58, s17, v122
    v_fmac_f32 v59, s17, v123
    v_and_b32 v120, 0xffff0000, v119
    v_lshlrev_b32 v121, 16, v119
    v_and_b32 v122, 0xffff0000, v118
    v_lshlrev_b32 v123, 16, v118
    v_fmac_f32 v60, s17, v120
    v_fmac_f32 v61, s17, v121
    v_fmac_f32 v62, s17, v122
    v_fmac_f32 v63, s17, v123
    s_mov_b32 s49, 0
L_SPIN16:
    ds_read_b32 v1, v219 offset:0
    s_waitcnt lgkmcnt(0)
    v_readfirstlane_b32 s48, v1
    s_nop 0
    s_cmp_ge_u32 s48, 3
    s_cbranch_scc1 L_SPUN17
    s_sleep 1
    s_add_u32 s49, s49, 1
    s_cmp_lt_u32 s49, 3200000
    s_cbranch_scc1 L_SPIN16
L_SPUN17:
    ds_read_b128 v[96:99], v223 offset:0
    ds_read_b128 v[100:103], v223 offset:1024
    ds_read_b128 v[104:107], v223 offset:2048
    ds_read_b128 v[108:111], v223 offset:3072
    s_waitcnt lgkmcnt(3)
    v_add_f32 v48, v48, v96
    v_add_f32 v49, v49, v97
    v_add_f32 v50, v50, v98
    v_add_f32 v51, v51, v99
    v_cvt_pk_bf16_f32 v124, v48, v49
    v_cvt_pk_bf16_f32 v125, v50, v51
    ds_write_b64 v226, v[124:125] offset:4096
    s_waitcnt lgkmcnt(3)
    v_add_f32 v52, v52, v100
    v_add_f32 v53, v53, v101
    v_add_f32 v54, v54, v102
    v_add_f32 v55, v55, v103
    v_cvt_pk_bf16_f32 v126, v52, v53
    v_cvt_pk_bf16_f32 v127, v54, v55
    ds_write_b64 v226, v[126:127] offset:4608
    s_waitcnt lgkmcnt(3)
    v_add_f32 v56, v56, v104
    v_add_f32 v57, v57, v105
    v_add_f32 v58, v58, v106
    v_add_f32 v59, v59, v107
    v_cvt_pk_bf16_f32 v128, v56, v57
    v_cvt_pk_bf16_f32 v129, v58, v59
    ds_write_b64 v226, v[128:129] offset:5120
    s_waitcnt lgkmcnt(3)
    v_add_f32 v60, v60, v108
    v_add_f32 v61, v61, v109
    v_add_f32 v62, v62, v110
    v_add_f32 v63, v63, v111
    v_cvt_pk_bf16_f32 v130, v60, v61
    v_cvt_pk_bf16_f32 v131, v62, v63
    ds_write_b64 v226, v[130:131] offset:5632
    ds_read_b128 v[96:99], v223 offset:4096
    ds_read_b128 v[100:103], v223 offset:5120
    ds_write_b128 v223, v[208:211]
    ds_write_b128 v223, v[212:215] offset:1024
    ds_read_b64 v[40:41], v227 offset:0
    ds_read_b64 v[42:43], v227 offset:16
    ds_read_b64 v[44:45], v227 offset:32
    ds_read_b64 v[46:47], v227 offset:48
    s_waitcnt lgkmcnt(7)
    global_store_dwordx4 v225, v[96:99], s[18:19] sc1
    s_waitcnt lgkmcnt(6)
    global_store_dwordx4 v225, v[100:103], s[18:19] offset:1024 sc1
    v_mov_b32 v131, s56
    v_mov_b32 v135, s56
    v_mov_b32 v139, s56
    s_waitcnt lgkmcnt(0)
    s_mov_b64 exec, 1
    ds_add_u32 v220, v221 offset:48
    s_mov_b64 exec, -1
    v_lshlrev_b32 v64, 16, v40
    v_and_b32 v65, 0xffff0000, v40
    v_lshlrev_b32 v66, 16, v41
    v_and_b32 v67, 0xffff0000, v41
    v_lshlrev_b32 v68, 16, v42
    v_and_b32 v69, 0xffff0000, v42
    v_lshlrev_b32 v70, 16, v43
    v_and_b32 v71, 0xffff0000, v43
    v_lshlrev_b32 v72, 16, v44
    v_and_b32 v73, 0xffff0000, v44
    v_lshlrev_b32 v74, 16, v45
    v_and_b32 v75, 0xffff0000, v45
    v_lshlrev_b32 v76, 16, v46
    v_and_b32 v77, 0xffff0000, v46
    v_lshlrev_b32 v78, 16, v47
    v_and_b32 v79, 0xffff0000, v47
    s_waitcnt vmcnt(0)
    s_mov_b64 exec, 1
    ds_add_rtn_u32 v24, v220, v221 offset:12
    s_mov_b64 exec, -1
    s_waitcnt lgkmcnt(0)
    v_readfirstlane_b32 s48, v24
    s_nop 0
    s_cmp_lg_u32 s48, 3
    s_cbranch_scc1 L_NOF18
    s_lshl_b32 s48, s59, 7
    s_add_u32 s48, s48, 12713984
    v_mov_b32 v26, s48
    v_mov_b32 v24, s56
    v_mov_b32 v25, s57
    s_mov_b64 exec, 1
    global_store_dwordx2 v26, v[24:25], s[18:19] sc1
    s_mov_b64 exec, -1
L_NOF18:
    s_setprio 0
    s_mov_b32 s49, 0
L_SPIN19:
    ds_read_b32 v1, v220 offset:36
    s_waitcnt lgkmcnt(0)
    v_readfirstlane_b32 s48, v1
    s_nop 0
    s_cmp_ge_u32 s48, 4
    s_cbranch_scc1 L_SPUN20
    s_sleep 1
    s_add_u32 s49, s49, 1
    s_cmp_lt_u32 s49, 3200000
    s_cbranch_scc1 L_SPIN19
L_SPUN20:
    s_setprio 2
    ds_read_b128 v[80:83], v233 offset:0
    ds_read_b128 v[84:87], v233 offset:1024
    ds_read_b128 v[88:91], v233 offset:2048
    ds_read_b128 v[92:95], v233 offset:3072
    ds_read_b128 v[96:99], v233 offset:21248
    ds_read_b128 v[100:103], v233 offset:22272
    ds_read_b128 v[104:107], v233 offset:23296
    ds_read_b128 v[108:111], v233 offset:24320
    s_waitcnt lgkmcnt(0)
    s_mov_b64 exec, 1
    ds_add_u32 v220, v221 offset:52
    s_mov_b64 exec, -1
    v_add_f32 v80, v80, v96
    v_add_f32 v81, v81, v97
    v_add_f32 v82, v82, v98
    v_add_f32 v83, v83, v99
    v_add_f32 v84, v84, v100
    v_add_f32 v85, v85, v101
    v_add_f32 v86, v86, v102
    v_add_f32 v87, v87, v103
    v_add_f32 v88, v88, v104
    v_add_f32 v89, v89, v105
    v_add_f32 v90, v90, v106
    v_add_f32 v91, v91, v107
    v_add_f32 v92, v92, v108
    v_add_f32 v93, v93, v109
    v_add_f32 v94, v94, v110
    v_add_f32 v95, v95, v111
    v_cvt_pk_bf16_f32 v128, v80, v81
    v_cvt_pk_bf16_f32 v129, v82, v83
    v_cvt_pk_bf16_f32 v130, v84, v85
    v_cvt_pk_bf16_f32 v132, v86, v87
    v_cvt_pk_bf16_f32 v133, v88, v89
    v_cvt_pk_bf16_f32 v134, v90, v91
    v_cvt_pk_bf16_f32 v136, v92, v93
    v_cvt_pk_bf16_f32 v137, v94, v95
    global_store_dwordx4 v234, v[128:131], s[18:19] offset:0 sc1
    global_store_dwordx4 v234, v[132:135], s[18:19] offset:1024 sc1
    global_store_dwordx4 v234, v[136:139], s[18:19] offset:2048 sc1
    s_load_dwordx2 s[0:1], s[18:19], s46 offset:0
    s_load_dwordx2 s[6:7], s[18:19], s46 offset:128
    s_load_dwordx2 s[8:9], s[18:19], s46 offset:256
    s_load_dwordx2 s[10:11], s[18:19], s46 offset:384
    s_load_dwordx2 s[24:25], s[18:19], s46 offset:512
    s_load_dwordx2 s[26:27], s[18:19], s46 offset:640
    s_load_dwordx2 s[30:31], s[18:19], s46 offset:768
    s_load_dwordx2 s[44:45], s[18:19], s46 offset:896
    s_waitcnt lgkmcnt(0)
    s_xor_b64 s[50:51], s[0:1], s[56:57]
    s_xor_b64 s[6:7], s[6:7], s[56:57]
    s_or_b64 s[50:51], s[50:51], s[6:7]
    s_xor_b64 s[8:9], s[8:9], s[56:57]
    s_or_b64 s[50:51], s[50:51], s[8:9]
    s_xor_b64 s[10:11], s[10:11], s[56:57]
    s_or_b64 s[50:51], s[50:51], s[10:11]
    s_xor_b64 s[24:25], s[24:25], s[56:57]
    s_or_b64 s[50:51], s[50:51], s[24:25]
    s_xor_b64 s[26:27], s[26:27], s[56:57]
    s_or_b64 s[50:51], s[50:51], s[26:27]
    s_xor_b64 s[30:31], s[30:31], s[56:57]
    s_or_b64 s[50:51], s[50:51], s[30:31]
    s_xor_b64 s[44:45], s[44:45], s[56:57]
    s_or_b64 s[50:51], s[50:51], s[44:45]
    s_cmp_eq_u64 s[50:51], 0
    s_cbranch_scc1 L_SPD21
    v_and_b32 v26, 7, v0
    v_lshl_add_u32 v26, v26, 7, s46
    s_mov_b32 s49, 0
L_POLL22:
    global_load_dwordx2 v[24:25], v26, s[18:19] sc1
    s_waitcnt vmcnt(0)
L_POLC23:
    v_cmp_ne_u64 vcc, s[56:57], v[24:25]
    s_nop 0
    s_cmp_eq_u64 vcc, 0
    s_cbranch_scc1 L_POLD24
    s_sleep 8
    s_add_u32 s49, s49, 1
    s_cmp_lt_u32 s49, 200000
    s_cbranch_scc1 L_POLL22
L_POLD24:
L_SPD21:
    s_mov_b64 exec, 1
    ds_add_u32 v220, v221 offset:52
    s_mov_b64 exec, -1
    s_setprio 0
    s_mov_b32 s49, 0
L_SPIN25:
    ds_read_b32 v1, v220 offset:52
    s_waitcnt lgkmcnt(0)
    v_readfirstlane_b32 s48, v1
    s_nop 0
    s_cmp_ge_u32 s48, 12
    s_cbranch_scc1 L_SPUN26
    s_sleep 1
    s_add_u32 s49, s49, 1
    s_cmp_lt_u32 s49, 3200000
    s_cbranch_scc1 L_SPIN25
L_SPUN26:
    s_setprio 2
    global_load_dword v32, v231, s[18:19] sc1
    global_load_dwordx4 v[24:27], v229, s[18:19] sc1
    global_load_dwordx4 v[28:31], v230, s[18:19] sc1
    s_waitcnt vmcnt(2)
    v_sub_f32 v33, 1.0, v32
    ds_write_b32 v232, v33
    v_mul_f32 v64, v32, v64
    v_mul_f32 v65, v32, v65
    v_mul_f32 v66, v32, v66
    v_mul_f32 v67, v32, v67
    v_mul_f32 v68, v32, v68
    v_mul_f32 v69, v32, v69
    v_mul_f32 v70, v32, v70
    v_mul_f32 v71, v32, v71
    v_mul_f32 v72, v32, v72
    v_mul_f32 v73, v32, v73
    v_mul_f32 v74, v32, v74
    v_mul_f32 v75, v32, v75
    v_mul_f32 v76, v32, v76
    v_mul_f32 v77, v32, v77
    v_mul_f32 v78, v32, v78
    v_mul_f32 v79, v32, v79
    s_waitcnt vmcnt(0)
    ds_write_b128 v223, v[24:27] offset:4608
    ds_write_b128 v223, v[28:31] offset:5632
    ds_read_b64_tr_b16 v[40:41], v228 offset:4608
    ds_read_b64_tr_b16 v[42:43], v228 offset:5120
    ds_read_b64_tr_b16 v[44:45], v228 offset:5632
    ds_read_b64_tr_b16 v[46:47], v228 offset:6144
    s_waitcnt lgkmcnt(3)
    v_lshlrev_b32 v48, 16, v40
    v_and_b32 v49, 0xffff0000, v40
    v_mul_f32 v64, v48, v64
    v_mul_f32 v65, v49, v65
    v_lshlrev_b32 v48, 16, v41
    v_and_b32 v49, 0xffff0000, v41
    v_mul_f32 v66, v48, v66
    v_mul_f32 v67, v49, v67
    ds_write_b128 v223, v[64:67] offset:0
    s_waitcnt lgkmcnt(3)
    v_lshlrev_b32 v48, 16, v42
    v_and_b32 v49, 0xffff0000, v42
    v_mul_f32 v68, v48, v68
    v_mul_f32 v69, v49, v69
    v_lshlrev_b32 v48, 16, v43
    v_and_b32 v49, 0xffff0000, v43
    v_mul_f32 v70, v48, v70
    v_mul_f32 v71, v49, v71
    ds_write_b128 v223, v[68:71] offset:1088
    s_waitcnt lgkmcnt(3)
    v_lshlrev_b32 v48, 16, v44
    v_and_b32 v49, 0xffff0000, v44
    v_mul_f32 v72, v48, v72
    v_mul_f32 v73, v49, v73
    v_lshlrev_b32 v48, 16, v45
    v_and_b32 v49, 0xffff0000, v45
    v_mul_f32 v74, v48, v74
    v_mul_f32 v75, v49, v75
    ds_write_b128 v223, v[72:75] offset:2176
    s_waitcnt lgkmcnt(3)
    v_lshlrev_b32 v48, 16, v46
    v_and_b32 v49, 0xffff0000, v46
    v_mul_f32 v76, v48, v76
    v_mul_f32 v77, v49, v77
    v_lshlrev_b32 v48, 16, v47
    v_and_b32 v49, 0xffff0000, v47
    v_mul_f32 v78, v48, v78
    v_mul_f32 v79, v49, v79
    ds_write_b128 v223, v[76:79] offset:3264
L_FINAL:
    s_nop 1
    s_lshr_b32 s50, s20, 2
    s_lshl_b32 s49, s23, 7
    s_mul_i32 s48, s50, 8704
    s_add_u32 s48, s48, s49
    s_add_u32 s48, s48, 49152
    v_and_b32 v2, 7, v0
    v_mul_u32_u24 v3, 1088, v2
    v_lshrrev_b32 v4, 3, v0
    v_lshl_add_u32 v3, v4, 4, v3
    v_add_u32 v3, s48, v3
    s_mul_i32 s48, s50, 21248
    s_add_u32 s48, s48, s49
    s_add_u32 s48, s48, 114688
    v_and_b32 v7, 3, v0
    v_mul_u32_u24 v7, 1088, v7
    v_bfe_u32 v5, v0, 2, 1
    v_mul_u32_u24 v5, 8320, v5
    v_add_u32 v7, v7, v5
    v_lshl_add_u32 v7, v4, 4, v7
    v_add_u32 v7, s48, v7
    s_lshl_b32 s48, s20, 5
    s_add_u32 s48, s48, 157440
    v_lshl_add_u32 v5, v4, 2, s48
    s_lshl_b32 s48, s16, 1
    s_add_u32 s48, s48, s3
    s_lshl_b32 s48, s48, 16
    s_lshl_b32 s49, s20, 13
    s_add_u32 s48, s48, s49
    s_lshr_b32 s49, s22, 2
    s_lshl_b32 s49, s49, 7
    s_add_u32 s48, s48, s49
    v_lshlrev_b32 v6, 10, v4
    v_lshl_add_u32 v6, v2, 4, v6
    v_add_u32 v6, s48, v6
    s_waitcnt lgkmcnt(0)
    s_barrier
    ds_read_b128 v[16:19], v3 offset:0
    ds_read_b128 v[20:23], v3 offset:512
    ds_read_b128 v[24:27], v3 offset:17408
    ds_read_b128 v[28:31], v3 offset:17920
    ds_read_b128 v[32:35], v7 offset:0
    ds_read_b128 v[36:39], v7 offset:512
    ds_read_b32 v8, v5
    s_waitcnt lgkmcnt(3)
    v_pk_add_f32 v[16:17], v[16:17], v[24:25]
    v_pk_add_f32 v[18:19], v[18:19], v[26:27]
    v_pk_add_f32 v[20:21], v[20:21], v[28:29]
    v_pk_add_f32 v[22:23], v[22:23], v[30:31]
    s_waitcnt lgkmcnt(0)
    v_fmac_f32 v32, v8, v16
    v_fmac_f32 v33, v8, v17
    v_fmac_f32 v34, v8, v18
    v_fmac_f32 v35, v8, v19
    v_fmac_f32 v36, v8, v20
    v_fmac_f32 v37, v8, v21
    v_fmac_f32 v38, v8, v22
    v_fmac_f32 v39, v8, v23
    v_cvt_pk_bf16_f32 v40, v32, v33
    v_cvt_pk_bf16_f32 v41, v34, v35
    v_cvt_pk_bf16_f32 v42, v36, v37
    v_cvt_pk_bf16_f32 v43, v38, v39
    global_store_dwordx4 v6, v[40:43], s[60:61]
L_END:
    s_endpgm
L_SPARE:
    s_cmp_eq_u32 s20, 4
    s_cbranch_scc1 L_ENG
    v_mov_b32 v32, 0
    v_mov_b32 v33, 0
    v_mov_b32 v34, 0
    v_mov_b32 v35, 0
    v_min_u32 v79, 3, v0
    v_lshlrev_b32 v79, 4, v79
    v_add_u32 v79, 157184, v79
    ds_write_b128 v79, v[32:35]
    s_waitcnt lgkmcnt(0)
    s_barrier
    s_branch L_SP1
L_ENG:
    s_setprio 3
    s_lshl_b32 s49, s21, 18
    s_lshl_b32 s50, s22, 16
    s_add_u32 s49, s49, s50
    v_lshl_add_u32 v1, v0, 10, s49
    v_min_u32 v2, 55, v0
    v_mul_u32_u24 v3, 4682, v2
    v_lshrrev_b32 v3, 16, v3
    v_mul_u32_u24 v4, 14, v3
    v_sub_u32 v4, v2, v4
    v_mul_u32_u24 v3, 3584, v3
    v_lshl_add_u32 v3, v4, 7, v3
    s_mul_i32 s49, s16, 14336
    s_mul_i32 s50, s3, 1792
    s_add_u32 s49, s49, s50
    v_add_u32 v3, s49, v3
    v_and_b32 v5, 31, v0
    v_lshlrev_b32 v5, 7, v5
    v_lshrrev_b32 v6, 5, v0
    v_mul_u32_u24 v6, 458752, v6
    v_add_u32 v6, v5, v6
    s_mul_i32 s49, s3, 917504
    s_lshl_b32 s50, s16, 12
    s_add_u32 s49, s49, s50
    v_add_u32 v6, s49, v6
    s_waitcnt lgkmcnt(0)
    s_mov_b32 s32, s4
    s_mov_b32 s33, s5
    s_mov_b32 s34, 2097152
    s_mov_b32 s35, 0x00020000
    s_mov_b32 s36, s24
    s_mov_b32 s37, s25
    s_mov_b32 s38, 1835008
    s_mov_b32 s39, 0x00020000
    s_mov_b32 s40, s26
    s_mov_b32 s41, s27
    s_mov_b32 s42, 1835008
    s_mov_b32 s43, 0x00020000
    buffer_load_dword v20, v3, s[36:39], 0 offen
    s_waitcnt vmcnt(3)
    buffer_load_dword v20, v3, s[40:43], 0 offen
    s_waitcnt vmcnt(3)
    s_barrier
    s_mov_b32 s49, 229376
    buffer_load_dword v20, v1, s[32:35], 0 offen offset:128
    s_waitcnt vmcnt(3)
    buffer_load_dword v20, v3, s[36:39], s49 offen
    s_waitcnt vmcnt(3)
    buffer_load_dword v20, v3, s[40:43], s49 offen
    s_waitcnt vmcnt(3)
    s_mov_b32 s49, 458752
    buffer_load_dword v20, v1, s[32:35], 0 offen offset:256
    s_waitcnt vmcnt(3)
    buffer_load_dword v20, v3, s[36:39], s49 offen
    s_waitcnt vmcnt(3)
    buffer_load_dword v20, v3, s[40:43], s49 offen
    s_waitcnt vmcnt(3)
    s_mov_b32 s49, 688128
    buffer_load_dword v20, v1, s[32:35], 0 offen offset:384
    s_waitcnt vmcnt(3)
    buffer_load_dword v20, v3, s[36:39], s49 offen
    s_waitcnt vmcnt(3)
    buffer_load_dword v20, v3, s[40:43], s49 offen
    s_waitcnt vmcnt(3)
    s_mov_b32 s49, 917504
    buffer_load_dword v20, v1, s[32:35], 0 offen offset:512
    s_waitcnt vmcnt(3)
    buffer_load_dword v20, v3, s[36:39], s49 offen
    s_waitcnt vmcnt(3)
    buffer_load_dword v20, v3, s[40:43], s49 offen
    s_waitcnt vmcnt(3)
    s_mov_b32 s49, 1146880
    buffer_load_dword v20, v1, s[32:35], 0 offen offset:640
    s_waitcnt vmcnt(3)
    buffer_load_dword v20, v3, s[36:39], s49 offen
    s_waitcnt vmcnt(3)
    buffer_load_dword v20, v3, s[40:43], s49 offen
    s_waitcnt vmcnt(3)
    s_mov_b32 s49, 1376256
    buffer_load_dword v20, v1, s[32:35], 0 offen offset:768
    s_waitcnt vmcnt(3)
    buffer_load_dword v20, v3, s[36:39], s49 offen
    s_waitcnt vmcnt(3)
    buffer_load_dword v20, v3, s[40:43], s49 offen
    s_waitcnt vmcnt(3)
    s_mov_b32 s49, 1605632
    buffer_load_dword v20, v1, s[32:35], 0 offen offset:896
    s_waitcnt vmcnt(3)
    buffer_load_dword v20, v3, s[36:39], s49 offen
    s_waitcnt vmcnt(3)
    buffer_load_dword v20, v3, s[40:43], s49 offen
    s_waitcnt vmcnt(3)
    s_mov_b32 s36, s28
    s_mov_b32 s37, s29
    s_mov_b32 s38, 1835008
    s_mov_b32 s39, 0x00020000
    s_mov_b32 s49, 0
    buffer_load_dword v20, v6, s[36:39], s49 offen
    s_waitcnt vmcnt(3)
    s_mov_b32 s49, 65536
    buffer_load_dword v20, v6, s[36:39], s49 offen
    s_waitcnt vmcnt(3)
    s_mov_b32 s49, 131072
    buffer_load_dword v20, v6, s[36:39], s49 offen
    s_waitcnt vmcnt(3)
    s_mov_b32 s49, 196608
    buffer_load_dword v20, v6, s[36:39], s49 offen
    s_waitcnt vmcnt(3)
    s_mov_b32 s49, 262144
    buffer_load_dword v20, v6, s[36:39], s49 offen
    s_waitcnt vmcnt(3)
    s_mov_b32 s49, 327680
    buffer_load_dword v20, v6, s[36:39], s49 offen
    s_waitcnt vmcnt(3)
    s_mov_b32 s49, 393216
    buffer_load_dword v20, v6, s[36:39], s49 offen
    s_waitcnt vmcnt(3)
L_SP1:
    s_setprio 3
    s_lshr_b32 s52, s23, 1
    s_and_b32 s53, s23, 1
    s_lshl_b32 s54, s59, 1
    s_add_u32 s54, s54, s52
    s_lshl_b32 s54, s54, 12
    s_mul_i32 s55, s52, 21248
    s_add_u32 s55, s55, 114688
    s_mul_i32 s58, s53, 8320
    s_add_u32 s58, s58, s55
    s_lshl_b32 s48, s53, 11
    v_lshl_add_u32 v64, v0, 4, s48
    v_subrev_u32 v65, 8, v64
    v_add_u32 v66, 1016, v64
    s_add_u32 s48, s54, 8388608
    v_add_u32 v67, s48, v64
    s_add_u32 s48, s55, 32
    v_add_u32 v78, s48, v64
    s_add_u32 s48, s54, 10485760
    v_add_u32 v225, s48, v64
    v_lshrrev_b32 v76, 1, v0
    v_mul_u32_u24 v76, 4160, v76
    v_and_b32 v77, 1, v0
    v_lshl_add_u32 v76, v77, 4, v76
    v_subrev_u32 v77, 8, v0
    v_and_b32 v77, 31, v77
    v_lshlrev_b32 v77, 4, v77
    v_add_u32 v77, 20736, v77
    v_cmp_gt_u32 vcc, 8, v0
    s_nop 1
    v_cndmask_b32 v76, v77, v76, vcc
    v_add_u32 v76, s55, v76
    v_mov_b32 v32, 0
    v_mov_b32 v33, 0
    v_mov_b32 v34, 0
    v_mov_b32 v35, 0
    v_min_u32 v79, 3, v0
    v_lshlrev_b32 v79, 4, v79
    v_add_u32 v79, 157184, v79
    v_not_b32 v56, v0
    v_and_b32 v56, 3, v56
    v_mul_u32_u24 v56, 4160, v56
    v_lshrrev_b32 v57, 4, v0
    v_lshl_add_u32 v56, v57, 4, v56
    v_bfe_u32 v58, v0, 2, 2
    v_lshl_add_u32 v56, v58, 3, v56
    s_lshl_b32 s48, s53, 8
    s_add_u32 s48, s48, s55
    s_add_u32 s49, s48, 8
    v_add_u32 v216, s49, v56
    v_and_b32 v58, 15, v0
    v_lshlrev_b32 v58, 5, v58
    v_lshlrev_b32 v56, 4, v57
    v_sub_u32 v56, v56, v58
    s_add_u32 s49, s48, 17120
    v_add_u32 v217, s49, v56
    v_mov_b32 v220, 157184
    v_mov_b32 v221, 1
    s_lshl_b32 s48, s23, 2
    s_add_u32 s48, s48, 157200
    v_mov_b32 v218, s48
    v_xor_b32 v219, 4, v218
    s_lshl_b32 s48, s55, 1
    s_sub_u32 s48, s48, s58
    s_add_u32 s48, s48, 8320
    v_lshl_add_u32 v222, v0, 4, s48
    v_lshl_add_u32 v223, v0, 4, s58
    s_lshl_b32 s48, s53, 11
    s_sub_u32 s48, s55, s48
    s_add_u32 s48, s48, 19192
    v_lshl_add_u32 v56, v57, 3, v58
    v_sub_u32 v224, s48, v56
    v_add_u32 v226, s58, v56
    s_lshl_b32 s50, s16, 1
    s_add_u32 s50, s50, s3
    s_lshl_b32 s50, s50, 1
    s_add_u32 s50, s50, s52
    s_lshr_b32 s51, s22, 2
    s_lshl_b32 s51, s51, 1
    s_add_u32 s51, s51, s53
    v_and_b32 v56, 31, v0
    v_lshrrev_b32 v57, 5, v0
    v_lshlrev_b32 v58, 6, v56
    v_lshl_add_u32 v58, v57, 3, v58
    v_add_u32 v227, s58, v58
    s_lshl_b32 s48, s50, 7
    s_add_u32 s48, s48, 12582912
    v_lshl_add_u32 v231, v56, 2, s48
    s_lshl_b32 s48, s52, 7
    s_add_u32 s48, s48, 157440
    v_lshl_add_u32 v232, v56, 2, s48
    v_bfe_u32 v58, v0, 2, 2
    v_lshl_add_u32 v58, v57, 2, v58
    v_lshlrev_b32 v58, 6, v58
    v_bfe_u32 v56, v0, 4, 1
    v_lshl_add_u32 v58, v56, 5, v58
    v_and_b32 v56, 3, v0
    v_lshl_add_u32 v58, v56, 3, v58
    v_add_u32 v228, s58, v58
    v_lshrrev_b32 v57, 2, v0
    v_lshlrev_b32 v56, 4, v56
    s_lshl_b32 s48, s51, 17
    s_lshl_b32 s49, s50, 6
    s_add_u32 s48, s48, s49
    s_add_u32 s48, s48, 10485760
    v_lshl_add_u32 v58, v57, 12, v56
    v_add_u32 v229, s48, v58
    v_add_u32 v230, 65536, v229
    s_lshl_b32 s48, s50, 15
    s_lshl_b32 s49, s51, 6
    s_add_u32 s48, s48, s49
    v_lshl_add_u32 v58, v57, 10, v56
    v_add_u32 v59, s48, v58
    v_add_u32 v60, 16384, v59
    s_mul_i32 s48, s52, 8320
    s_lshl_b32 s49, s53, 12
    s_add_u32 s48, s48, s49
    s_add_u32 s48, s48, 114688
    v_lshl_add_u32 v233, v0, 4, s48
    s_lshl_b32 s48, s59, 14
    s_lshl_b32 s49, s23, 12
    s_add_u32 s48, s48, s49
    s_add_u32 s48, s48, 16777216
    v_lshl_add_u32 v234, v0, 4, s48
    v_lshrrev_b32 v12, 3, v0
    v_lshlrev_b32 v12, 10, v12
    v_bfe_u32 v13, v0, 4, 1
    v_lshlrev_b32 v13, 2, v13
    v_and_b32 v14, 7, v0
    v_xor_b32 v13, v13, v14
    v_lshl_add_u32 v12, v13, 4, v12
    v_add_u32 v13, 15360, v12
    v_add_u32 v14, 456704, v12
    v_add_u32 v15, 472064, v12
    s_barrier
    s_load_dwordx2 s[56:57], s[62:63], 0
    s_lshl_b32 s48, s59, 2
    s_load_dword s17, s[14:15], s48
    s_add_u32 s40, s12, s54
    s_addc_u32 s41, s13, 0
    s_mov_b32 s42, 4096
    s_mov_b32 s43, 0x00020000
    buffer_load_dwordx2 v[16:17], v65, s[40:43], 0 offen
    buffer_load_dwordx4 v[18:21], v64, s[40:43], 0 offen
    buffer_load_dwordx2 v[24:25], v66, s[40:43], 0 offen
    buffer_load_dwordx4 v[26:29], v64, s[40:43], 0 offen offset:1024
    global_load_dwordx4 v[208:211], v59, s[4:5]
    global_load_dwordx4 v[212:215], v60, s[4:5]
    s_waitcnt lgkmcnt(0)
    s_cmp_lg_u32 s56, 0
    s_cbranch_scc1 L_TAGD28
    s_mov_b32 s49, 0
    v_mov_b32 v54, 0
L_TAG27:
    s_sleep 8
    global_load_dwordx2 v[52:53], v54, s[62:63] sc1
    s_waitcnt vmcnt(0)
    v_readfirstlane_b32 s56, v52
    v_readfirstlane_b32 s57, v53
    s_add_u32 s49, s49, 1
    s_cmp_lt_u32 s49, 200000
    s_cselect_b32 s48, s56, 1
    s_cmp_eq_u32 s48, 0
    s_cbranch_scc1 L_TAG27
    s_nop 4
L_TAGD28:
    s_lshl_b32 s46, s21, 12
    s_lshl_b32 s49, s23, 10
    s_add_u32 s46, s46, s49
    s_add_u32 s46, s46, 12648448
    s_load_dwordx2 s[0:1], s[18:19], s46 offset:0
    s_load_dwordx2 s[6:7], s[18:19], s46 offset:128
    s_load_dwordx2 s[8:9], s[18:19], s46 offset:256
    s_load_dwordx2 s[10:11], s[18:19], s46 offset:384
    s_load_dwordx2 s[24:25], s[18:19], s46 offset:512
    s_load_dwordx2 s[26:27], s[18:19], s46 offset:640
    s_load_dwordx2 s[30:31], s[18:19], s46 offset:768
    s_load_dwordx2 s[44:45], s[18:19], s46 offset:896
    s_waitcnt lgkmcnt(0)
    s_xor_b64 s[50:51], s[0:1], s[56:57]
    s_xor_b64 s[6:7], s[6:7], s[56:57]
    s_or_b64 s[50:51], s[50:51], s[6:7]
    s_xor_b64 s[8:9], s[8:9], s[56:57]
    s_or_b64 s[50:51], s[50:51], s[8:9]
    s_xor_b64 s[10:11], s[10:11], s[56:57]
    s_or_b64 s[50:51], s[50:51], s[10:11]
    s_xor_b64 s[24:25], s[24:25], s[56:57]
    s_or_b64 s[50:51], s[50:51], s[24:25]
    s_xor_b64 s[26:27], s[26:27], s[56:57]
    s_or_b64 s[50:51], s[50:51], s[26:27]
    s_xor_b64 s[30:31], s[30:31], s[56:57]
    s_or_b64 s[50:51], s[50:51], s[30:31]
    s_xor_b64 s[44:45], s[44:45], s[56:57]
    s_or_b64 s[50:51], s[50:51], s[44:45]
    s_cmp_eq_u64 s[50:51], 0
    s_cbranch_scc1 L_SPD29
    v_and_b32 v54, 7, v0
    v_lshl_add_u32 v54, v54, 7, s46
    s_mov_b32 s49, 0
L_POLL30:
    global_load_dwordx2 v[52:53], v54, s[18:19] sc1
    s_waitcnt vmcnt(0)
L_POLC31:
    v_cmp_ne_u64 vcc, s[56:57], v[52:53]
    s_nop 0
    s_cmp_eq_u64 vcc, 0
    s_cbranch_scc1 L_POLD32
    s_sleep 8
    s_add_u32 s49, s49, 1
    s_cmp_lt_u32 s49, 200000
    s_cbranch_scc1 L_POLL30
L_POLD32:
L_SPD29:
    s_barrier
    global_load_dwordx4 v[68:71], v67, s[18:19] sc1
    global_load_dwordx4 v[72:75], v67, s[18:19] offset:1024 sc1
    s_mul_i32 s48, s3, 917504
    s_lshr_b32 s49, s22, 2
    s_lshl_b32 s49, s49, 7
    s_add_u32 s48, s48, s49
    s_sub_u32 s49, 1835008, s48
    s_add_u32 s32, s28, s48
    s_addc_u32 s33, s29, 0
    s_mov_b32 s34, s49
    s_mov_b32 s35, 0x00020000
    s_lshr_b32 s48, s23, 1
    s_lshl_b32 s48, s48, 15
    s_and_b32 s49, s23, 1
    s_lshl_b32 s49, s49, 13
    s_add_u32 s48, s48, s49
    s_add_u32 s49, s48, 0
    s_lshl_b32 s48, s23, 12
    s_add_u32 m0, s48, 98304
    s_nop 0
    buffer_load_dwordx4 v12, s[32:35], s49 offen offset:0 lds
    buffer_load_dwordx4 v13, s[32:35], s49 offen offset:1024 lds
    buffer_load_dwordx4 v14, s[32:35], s49 offen offset:2048 lds
    buffer_load_dwordx4 v15, s[32:35], s49 offen offset:3072 lds
    s_waitcnt vmcnt(4)
    s_branch L_BUILD
L_COMPUTE:
    v_lshrrev_b32 v10, 5, v0
    v_and_b32 v11, 31, v0
    s_lshl_b32 s51, s20, 11
    v_lshlrev_b32 v12, 10, v10
    v_lshl_add_u32 v12, v11, 2, v12
    v_add_u32 v12, s51, v12
    v_add_u32 v12, 114688, v12
    v_lshlrev_b32 v14, 4, v11
    v_add_u32 v14, 132096, v14
    s_memrealtime s[56:57]
    s_waitcnt lgkmcnt(0)
    s_cmp_ge_u32 s22, 4
    s_cbranch_scc1 L_NOSPK
    s_or_b32 s48, s2, s20
    s_cmp_lg_u32 s48, 0
    s_cbranch_scc1 L_NOTAG33
    s_or_b32 s56, s56, 1
    v_mov_b32 v2, s56
    v_mov_b32 v3, s57
    v_mov_b32 v1, 0
    s_mov_b64 exec, 1
    global_store_dwordx2 v1, v[2:3], s[62:63] sc1
    s_mov_b64 exec, -1
L_NOTAG33:
    s_barrier
    v_lshrrev_b32 v16, 3, v0
    v_lshlrev_b32 v16, 10, v16
    v_and_b32 v17, 7, v0
    v_lshl_add_u32 v16, v17, 4, v16
    v_add_u32 v17, 7168, v16
    s_lshl_b32 s50, s22, 16
    s_lshl_b32 s51, s21, 7
    s_add_u32 s50, s50, s51
    s_cmp_eq_u32 s23, 1
    s_cbranch_scc1 L_KD34
    s_mov_b32 s44, s6
    s_mov_b32 s45, s7
    s_mov_b32 s46, 2097152
    s_mov_b32 s47, 0x00020000
    s_cmp_lg_u32 s23, 0
    s_cbranch_scc1 L_KD35
    s_sub_u32 s51, s50, 8192
    v_add_u32 v18, s51, v16
    v_cmp_gt_u32 vcc, 40, v0
    s_nop 1
    v_cndmask_b32 v18, v18, -1, vcc
    s_mov_b32 m0, 114688
    s_nop 0
    buffer_load_dwordx4 v18, s[44:47], 0 offen lds
    s_branch L_KD35
L_KD34:
    s_lshl_b32 s51, s21, 9
    s_add_u32 s44, s10, s51
    s_addc_u32 s45, s11, 0
    s_mov_b32 s46, 512
    s_mov_b32 s47, 0x00020000
    v_lshlrev_b32 v18, 4, v0
    s_mov_b32 m0, 132096
    s_nop 0
    buffer_load_dwordx4 v18, s[44:47], 0 offen lds
    s_mov_b32 s44, s6
    s_mov_b32 s45, s7
    s_mov_b32 s46, 2097152
    s_mov_b32 s47, 0x00020000
L_KD35:
    s_mov_b32 s52, s8
    s_mov_b32 s53, s9
    s_mov_b32 s54, 2097152
    s_mov_b32 s55, 0x00020000
    s_lshl_b32 s51, s23, 14
    s_add_u32 s50, s50, s51
    s_lshl_b32 s51, s23, 11
    s_add_u32 m0, s51, 115712
    s_nop 0
    buffer_load_dwordx4 v16, s[44:47], s50 offen lds
    buffer_load_dwordx4 v17, s[44:47], s50 offen offset:1024 lds
    s_add_u32 m0, s51, 123904
    s_nop 0
    buffer_load_dwordx4 v16, s[52:55], s50 offen lds
    buffer_load_dwordx4 v17, s[52:55], s50 offen offset:1024 lds
L_NOSPK:
    s_lshl_b32 s51, s20, 1
    v_add_u32 v10, s51, v10
    v_and_b32 v15, 7, v0
    v_xor_b32 v10, v10, v15
    v_lshlrev_b32 v10, 4, v10
    v_lshl_add_u32 v10, v11, 8, v10
    v_add_u32 v24, 98304, v10
    s_setprio 1
    v_mov_b32 v232, v0
    s_and_b32 s54, s20, 1
    s_lshr_b32 s55, s20, 1
    v_and_b32 v1, 15, v0
    v_lshlrev_b32 v1, 7, v1
    v_add_u32 v1, 49152, v1
    v_lshrrev_b32 v2, 4, v0
    v_bfe_u32 v3, v0, 1, 3
    v_xor_b32 v3, v2, v3
    v_lshl_add_u32 v224, v3, 4, v1
    v_xor_b32 v225, 64, v224
    v_bfe_u32 v1, v0, 2, 2
    v_lshl_add_u32 v3, v2, 3, v1
    v_lshlrev_b32 v3, 8, v3
    v_and_b32 v2, 1, v2
    v_lshl_add_u32 v1, v1, 1, v2
    s_lshl_b32 s50, s20, 1
    v_xor_b32 v1, s50, v1
    v_lshl_add_u32 v3, v1, 5, v3
    v_and_b32 v1, 3, v0
    v_lshl_add_u32 v3, v1, 3, v3
    v_add_u32 v226, 65536, v3
    v_xor_b32 v227, 32, v226
    v_lshrrev_b32 v1, 4, v0
    v_lshlrev_b32 v1, 9, v1
    v_and_b32 v2, 15, v0
    v_lshl_add_u32 v231, v2, 4, v1
    v_lshlrev_b32 v230, 4, v0
    s_lshl_b32 s48, s16, 2
    s_add_u32 s48, s48, s54
    s_lshl_b32 s49, s3, 1
    s_add_u32 s41, s48, s49
    s_sub_u32 s40, s48, s49
    s_add_u32 s40, s40, 2
    s_mul_i32 s40, s40, 112
    s_mul_i32 s41, s41, 112
    s_mul_i32 s48, s54, 112
    s_lshl_b32 s49, s17, 3
    s_sub_u32 s48, s49, s48
    s_lshl_b32 s49, s20, 1
    s_add_u32 s48, s48, s49
    s_add_u32 s8, s40, s48
    s_add_u32 s10, s41, s48
    s_lshl_b32 s8, s8, 10
    s_lshl_b32 s10, s10, 10
    s_add_u32 s9, s8, 114688
    s_add_u32 s11, s10, 114688
    s_mul_i32 s48, s3, 56
    s_mul_i32 s49, s55, 28
    s_add_u32 s48, s48, s49
    s_add_u32 s42, s40, s48
    s_add_u32 s43, s41, s48
    s_lshl_b32 s42, s42, 10
    s_lshl_b32 s43, s43, 10
    s_add_u32 s44, s18, 0
    s_addc_u32 s45, s19, 0
    s_mov_b32 s46, 7340032
    s_mov_b32 s47, 0x00020000
    v_lshrrev_b32 v235, 3, v0
    v_lshlrev_b32 v235, 10, v235
    v_bfe_u32 v236, v0, 4, 1
    v_lshlrev_b32 v236, 2, v236
    v_and_b32 v237, 7, v0
    v_xor_b32 v236, v236, v237
    v_lshl_add_u32 v235, v236, 4, v235
    v_add_u32 v236, 15360, v235
    v_add_u32 v237, 456704, v235
    v_add_u32 v238, 472064, v235
    s_mul_i32 s48, s3, 917504
    s_lshr_b32 s49, s22, 2
    s_lshl_b32 s49, s49, 7
    s_add_u32 s48, s48, s49
    s_sub_u32 s49, 1835008, s48
    s_add_u32 s36, s28, s48
    s_addc_u32 s37, s29, 0
    s_mov_b32 s38, s49
    s_mov_b32 s39, 0x00020000
    v_mov_b32 v233, 157184
    v_mov_b32 v234, 1
    v_bfe_u32 v1, v0, 2, 2
    v_lshrrev_b32 v2, 5, v0
    v_lshl_add_u32 v2, v2, 2, v1
    v_lshlrev_b32 v2, 7, v2
    v_lshrrev_b32 v1, 1, v1
    v_lshl_add_u32 v2, v1, 6, v2
    v_bfe_u32 v1, v0, 4, 1
    v_lshl_add_u32 v2, v1, 5, v2
    v_and_b32 v1, 3, v0
    v_lshl_add_u32 v2, v1, 3, v2
    s_lshl_b32 s48, s55, 11
    v_add_u32 v239, s48, v2
    v_xor_b32 v240, 64, v239
    v_add_u32 v241, 65536, v239
    v_add_u32 v242, 65536, v240
    s_lshl_b32 s48, s21, 5
    s_and_b32 s49, s22, 3
    s_add_u32 s48, s48, s49
    s_lshl_b32 s48, s48, 7
    s_add_u32 s50, s48, 12746752
    v_and_b32 v2, 7, v0
    v_lshl_add_u32 v244, v2, 9, s50
    s_mul_i32 s49, s55, 1536
    s_add_u32 s48, s48, s49
    s_add_u32 s48, s48, 12681728
    v_lshl_add_u32 v243, v1, 9, s48
    s_mul_i32 s48, s55, 21248
    s_mul_i32 s49, s54, 8320
    s_add_u32 s48, s48, s49
    s_add_u32 s48, s48, 114688
    v_lshl_add_u32 v245, v0, 4, s48
    s_mul_i32 s48, s55, 17408
    s_mul_i32 s49, s54, 8704
    s_add_u32 s48, s48, s49
    s_add_u32 s48, s48, 49152
    v_lshl_add_u32 v246, v0, 4, s48
    s_xor_b32 s48, s59, 32
    s_lshl_b32 s48, s48, 14
    s_lshl_b32 s49, s54, 13
    s_add_u32 s48, s48, s49
    s_lshl_b32 s49, s55, 12
    s_add_u32 s48, s48, s49
    s_add_u32 s48, s48, 16777216
    v_lshl_add_u32 v247, v0, 4, s48
    s_cmp_ge_u32 s22, 4
    s_cbranch_scc1 L_BM1
    s_waitcnt vmcnt(0)
    s_mov_b64 exec, 1
    ds_add_u32 v233, v234 offset:56
    s_mov_b64 exec, -1
    s_mov_b32 s49, 0
L_SPIN36:
    ds_read_b32 v1, v233 offset:56
    s_waitcnt lgkmcnt(0)
    v_readfirstlane_b32 s48, v1
    s_nop 0
    s_cmp_ge_u32 s48, 4
    s_cbranch_scc1 L_SPUN37
    s_sleep 1
    s_add_u32 s49, s49, 1
    s_cmp_lt_u32 s49, 3200000
    s_cbranch_scc1 L_SPIN36
L_SPUN37:
    s_branch L_BM1D
L_BM1:
    s_barrier
L_BM1D:
    ds_read_b128 v[60:63], v14
    ds_read_b32 v40, v12 offset:640
    ds_read_b32 v41, v12 offset:768
    ds_read_b32 v42, v12 offset:896
    ds_read_b32 v43, v12 offset:1024
    ds_read_b32 v44, v12 offset:1152
    ds_read_b32 v45, v12 offset:1280
    ds_read_b32 v46, v12 offset:1408
    ds_read_b32 v47, v12 offset:1536
    ds_read_b32 v48, v12 offset:1664
    ds_read_b32 v49, v12 offset:1792
    ds_read_b32 v50, v12 offset:1920
    ds_read_b32 v51, v12 offset:9216
    ds_read_b32 v52, v12 offset:9344
    ds_read_b32 v53, v12 offset:9472
    ds_read_b32 v54, v12 offset:9600
    ds_read_b32 v55, v12 offset:9728
    ds_read_b32 v56, v12 offset:9856
    ds_read_b32 v57, v12 offset:9984
    ds_read_b32 v58, v12 offset:10112
    s_waitcnt lgkmcnt(8)
    v_lshlrev_b32 v86, 16, v60
    v_lshlrev_b32 v87, 16, v62
    v_and_b32 v88, 0xffff0000, v60
    v_and_b32 v89, 0xffff0000, v62
    v_lshlrev_b32 v90, 16, v61
    v_lshlrev_b32 v91, 16, v63
    v_and_b32 v92, 0xffff0000, v61
    v_and_b32 v93, 0xffff0000, v63
    v_lshlrev_b32 v64, 16, v40
    v_and_b32 v65, 0xffff0000, v40
    v_lshlrev_b32 v66, 16, v41
    v_and_b32 v67, 0xffff0000, v41
    v_lshlrev_b32 v68, 16, v42
    v_and_b32 v69, 0xffff0000, v42
    v_lshlrev_b32 v70, 16, v43
    v_and_b32 v71, 0xffff0000, v43
    v_lshlrev_b32 v72, 16, v44
    v_and_b32 v73, 0xffff0000, v44
    v_lshlrev_b32 v74, 16, v45
    v_and_b32 v75, 0xffff0000, v45
    v_lshlrev_b32 v76, 16, v46
    v_and_b32 v77, 0xffff0000, v46
    v_lshlrev_b32 v78, 16, v47
    v_and_b32 v79, 0xffff0000, v47
    v_lshlrev_b32 v80, 16, v48
    v_and_b32 v81, 0xffff0000, v48
    v_lshlrev_b32 v82, 16, v49
    v_and_b32 v83, 0xffff0000, v49
    v_lshlrev_b32 v84, 16, v50
    v_and_b32 v85, 0xffff0000, v50
    v_pk_mul_f32 v[110:111], v[64:65], v[92:93]
    v_pk_mul_f32 v[112:113], v[66:67], v[92:93]
    v_pk_mul_f32 v[114:115], v[68:69], v[92:93]
    v_pk_mul_f32 v[116:117], v[70:71], v[92:93]
    v_pk_mul_f32 v[118:119], v[72:73], v[92:93]
    v_pk_mul_f32 v[120:121], v[74:75], v[92:93]
    v_pk_mul_f32 v[122:123], v[76:77], v[92:93]
    v_pk_mul_f32 v[124:125], v[78:79], v[92:93]
    v_pk_fma_f32 v[110:111], v[66:67], v[90:91], v[110:111]
    v_pk_fma_f32 v[112:113], v[68:69], v[90:91], v[112:113]
    v_pk_fma_f32 v[114:115], v[70:71], v[90:91], v[114:115]
    v_pk_fma_f32 v[116:117], v[72:73], v[90:91], v[116:117]
    v_pk_fma_f32 v[118:119], v[74:75], v[90:91], v[118:119]
    v_pk_fma_f32 v[120:121], v[76:77], v[90:91], v[120:121]
    v_pk_fma_f32 v[122:123], v[78:79], v[90:91], v[122:123]
    v_pk_fma_f32 v[124:125], v[80:81], v[90:91], v[124:125]
    v_pk_fma_f32 v[110:111], v[68:69], v[88:89], v[110:111]
    v_pk_fma_f32 v[112:113], v[70:71], v[88:89], v[112:113]
    v_pk_fma_f32 v[114:115], v[72:73], v[88:89], v[114:115]
    v_pk_fma_f32 v[116:117], v[74:75], v[88:89], v[116:117]
    v_pk_fma_f32 v[118:119], v[76:77], v[88:89], v[118:119]
    v_pk_fma_f32 v[120:121], v[78:79], v[88:89], v[120:121]
    v_pk_fma_f32 v[122:123], v[80:81], v[88:89], v[122:123]
    v_pk_fma_f32 v[124:125], v[82:83], v[88:89], v[124:125]
    v_pk_fma_f32 v[110:111], v[70:71], v[86:87], v[110:111]
    v_pk_fma_f32 v[112:113], v[72:73], v[86:87], v[112:113]
    v_pk_fma_f32 v[114:115], v[74:75], v[86:87], v[114:115]
    v_pk_fma_f32 v[116:117], v[76:77], v[86:87], v[116:117]
    v_pk_fma_f32 v[118:119], v[78:79], v[86:87], v[118:119]
    v_pk_fma_f32 v[120:121], v[80:81], v[86:87], v[120:121]
    v_pk_fma_f32 v[122:123], v[82:83], v[86:87], v[122:123]
    v_pk_fma_f32 v[124:125], v[84:85], v[86:87], v[124:125]
    s_waitcnt lgkmcnt(0)
    v_lshlrev_b32 v94, 16, v51
    v_and_b32 v95, 0xffff0000, v51
    v_lshlrev_b32 v96, 16, v52
    v_and_b32 v97, 0xffff0000, v52
    v_lshlrev_b32 v98, 16, v53
    v_and_b32 v99, 0xffff0000, v53
    v_lshlrev_b32 v100, 16, v54
    v_and_b32 v101, 0xffff0000, v54
    v_lshlrev_b32 v102, 16, v55
    v_and_b32 v103, 0xffff0000, v55
    v_lshlrev_b32 v104, 16, v56
    v_and_b32 v105, 0xffff0000, v56
    v_lshlrev_b32 v106, 16, v57
    v_and_b32 v107, 0xffff0000, v57
    v_lshlrev_b32 v108, 16, v58
    v_and_b32 v109, 0xffff0000, v58
    v_pk_mul_f32 v[110:111], v[110:111], v[94:95]
    v_pk_mul_f32 v[112:113], v[112:113], v[96:97]
    v_pk_mul_f32 v[114:115], v[114:115], v[98:99]
    v_pk_mul_f32 v[116:117], v[116:117], v[100:101]
    v_pk_mul_f32 v[118:119], v[118:119], v[102:103]
    v_pk_mul_f32 v[120:121], v[120:121], v[104:105]
    v_pk_mul_f32 v[122:123], v[122:123], v[106:107]
    v_pk_mul_f32 v[124:125], v[124:125], v[108:109]
    v_cvt_pk_bf16_f32 v16, v124, v122
    v_cvt_pk_bf16_f32 v17, v120, v118
    v_cvt_pk_bf16_f32 v18, v116, v114
    v_cvt_pk_bf16_f32 v19, v112, v110
    ds_write_b128 v24, v[16:19] offset:0
    v_cvt_pk_bf16_f32 v20, v125, v123
    v_cvt_pk_bf16_f32 v21, v121, v119
    v_cvt_pk_bf16_f32 v22, v117, v115
    v_cvt_pk_bf16_f32 v23, v113, v111
    ds_write_b128 v24, v[20:23] offset:128
    s_waitcnt lgkmcnt(0)
    s_cmp_lt_u32 s22, 4
    s_cbranch_scc1 L_SPC
    s_barrier
    ds_read_b128 v[128:131], v224 offset:0
    ds_read_b64_tr_b16 v[160:161], v226 offset:0
    ds_read_b64_tr_b16 v[162:163], v226 offset:1024
    ds_read_b64_tr_b16 v[164:165], v226 offset:16384
    ds_read_b64_tr_b16 v[166:167], v226 offset:17408
    ds_read_b64_tr_b16 v[168:169], v227 offset:0
    ds_read_b64_tr_b16 v[170:171], v227 offset:1024
    ds_read_b64_tr_b16 v[172:173], v227 offset:16384
    ds_read_b64_tr_b16 v[174:175], v227 offset:17408
    ds_read_b128 v[132:135], v224 offset:2048
    ds_read_b128 v[136:139], v224 offset:4096
    ds_read_b128 v[140:143], v224 offset:6144
    ds_read_b128 v[144:147], v224 offset:8192
    ds_read_b128 v[148:151], v224 offset:10240
    ds_read_b128 v[152:155], v224 offset:12288
    ds_read_b128 v[156:159], v224 offset:14336
    s_waitcnt lgkmcnt(13)
    v_mfma_f32_16x16x32_bf16 v[0:3], v[160:163], v[128:131], 0
    ds_read_b128 v[176:179], v225 offset:0
    s_waitcnt lgkmcnt(12)
    v_mfma_f32_16x16x32_bf16 v[4:7], v[164:167], v[128:131], 0
    ds_read_b64_tr_b16 v[208:209], v226 offset:8192
    s_waitcnt lgkmcnt(11)
    v_mfma_f32_16x16x32_bf16 v[8:11], v[168:171], v[128:131], 0
    ds_read_b64_tr_b16 v[210:211], v226 offset:9216
    s_waitcnt lgkmcnt(10)
    v_mfma_f32_16x16x32_bf16 v[12:15], v[172:175], v[128:131], 0
    ds_read_b64_tr_b16 v[212:213], v226 offset:24576
    s_waitcnt lgkmcnt(10)
    v_mfma_f32_16x16x32_bf16 v[16:19], v[160:163], v[132:135], 0
    ds_read_b64_tr_b16 v[214:215], v226 offset:25600
    v_mfma_f32_16x16x32_bf16 v[20:23], v[164:167], v[132:135], 0
    ds_read_b64_tr_b16 v[216:217], v227 offset:8192
    v_mfma_f32_16x16x32_bf16 v[24:27], v[168:171], v[132:135], 0
    ds_read_b64_tr_b16 v[218:219], v227 offset:9216
    v_mfma_f32_16x16x32_bf16 v[28:31], v[172:175], v[132:135], 0
    ds_read_b64_tr_b16 v[220:221], v227 offset:24576
    s_waitcnt lgkmcnt(13)
    v_mfma_f32_16x16x32_bf16 v[32:35], v[160:163], v[136:139], 0
    ds_read_b64_tr_b16 v[222:223], v227 offset:25600
    v_mfma_f32_16x16x32_bf16 v[36:39], v[164:167], v[136:139], 0
    ds_read_b128 v[180:183], v225 offset:2048
    v_mfma_f32_16x16x32_bf16 v[40:43], v[168:171], v[136:139], 0
    ds_read_b128 v[184:187], v225 offset:4096
    v_mfma_f32_16x16x32_bf16 v[44:47], v[172:175], v[136:139], 0
    ds_read_b128 v[188:191], v225 offset:6144
    s_waitcnt lgkmcnt(14)
    v_mfma_f32_16x16x32_bf16 v[48:51], v[160:163], v[140:143], 0
    ds_read_b128 v[192:195], v225 offset:8192
    v_mfma_f32_16x16x32_bf16 v[52:55], v[164:167], v[140:143], 0
    ds_read_b128 v[196:199], v225 offset:10240
    v_mfma_f32_16x16x32_bf16 v[56:59], v[168:171], v[140:143], 0
    ds_read_b128 v[200:203], v225 offset:12288
    v_mfma_f32_16x16x32_bf16 v[60:63], v[172:175], v[140:143], 0
    ds_read_b128 v[204:207], v225 offset:14336
    v_mfma_f32_16x16x32_bf16 v[64:67], v[160:163], v[144:147], 0
    v_mfma_f32_16x16x32_bf16 v[68:71], v[164:167], v[144:147], 0
    v_mfma_f32_16x16x32_bf16 v[72:75], v[168:171], v[144:147], 0
    v_mfma_f32_16x16x32_bf16 v[76:79], v[172:175], v[144:147], 0
    v_mfma_f32_16x16x32_bf16 v[80:83], v[160:163], v[148:151], 0
    v_mfma_f32_16x16x32_bf16 v[84:87], v[164:167], v[148:151], 0
    v_mfma_f32_16x16x32_bf16 v[88:91], v[168:171], v[148:151], 0
    v_mfma_f32_16x16x32_bf16 v[92:95], v[172:175], v[148:151], 0
    s_waitcnt lgkmcnt(14)
    v_mfma_f32_16x16x32_bf16 v[96:99], v[160:163], v[152:155], 0
    v_mfma_f32_16x16x32_bf16 v[100:103], v[164:167], v[152:155], 0
    v_mfma_f32_16x16x32_bf16 v[104:107], v[168:171], v[152:155], 0
    v_mfma_f32_16x16x32_bf16 v[108:111], v[172:175], v[152:155], 0
    v_mfma_f32_16x16x32_bf16 v[112:115], v[160:163], v[156:159], 0
    v_mfma_f32_16x16x32_bf16 v[116:119], v[164:167], v[156:159], 0
    v_mfma_f32_16x16x32_bf16 v[120:123], v[168:171], v[156:159], 0
    v_mfma_f32_16x16x32_bf16 v[124:127], v[172:175], v[156:159], 0
    s_waitcnt lgkmcnt(0)
    v_mfma_f32_16x16x32_bf16 v[0:3], v[208:211], v[176:179], v[0:3]
    v_add_u32 v224, 4294918144, v224
    v_add_u32 v225, 4294918144, v225
    v_mfma_f32_16x16x32_bf16 v[4:7], v[212:215], v[176:179], v[4:7]
    v_add_u32 v226, 4294918144, v226
    v_add_u32 v227, 4294918144, v227
    s_barrier
    v_mfma_f32_16x16x32_bf16 v[8:11], v[216:219], v[176:179], v[8:11]
    ds_read_b128 v[128:131], v224 offset:0
    v_mfma_f32_16x16x32_bf16 v[12:15], v[220:223], v[176:179], v[12:15]
    ds_read_b64_tr_b16 v[160:161], v226 offset:0
    v_mfma_f32_16x16x32_bf16 v[16:19], v[208:211], v[180:183], v[16:19]
    ds_read_b64_tr_b16 v[162:163], v226 offset:1024
    v_mfma_f32_16x16x32_bf16 v[20:23], v[212:215], v[180:183], v[20:23]
    ds_read_b64_tr_b16 v[164:165], v226 offset:16384
    v_mfma_f32_16x16x32_bf16 v[24:27], v[216:219], v[180:183], v[24:27]
    ds_read_b64_tr_b16 v[166:167], v226 offset:17408
    v_mfma_f32_16x16x32_bf16 v[28:31], v[220:223], v[180:183], v[28:31]
    ds_read_b64_tr_b16 v[168:169], v227 offset:0
    v_mfma_f32_16x16x32_bf16 v[32:35], v[208:211], v[184:187], v[32:35]
    ds_read_b64_tr_b16 v[170:171], v227 offset:1024
    v_mfma_f32_16x16x32_bf16 v[36:39], v[212:215], v[184:187], v[36:39]
    ds_read_b64_tr_b16 v[172:173], v227 offset:16384
    v_mfma_f32_16x16x32_bf16 v[40:43], v[216:219], v[184:187], v[40:43]
    ds_read_b64_tr_b16 v[174:175], v227 offset:17408
    v_mfma_f32_16x16x32_bf16 v[44:47], v[220:223], v[184:187], v[44:47]
    ds_read_b128 v[132:135], v224 offset:2048
    v_mfma_f32_16x16x32_bf16 v[48:51], v[208:211], v[188:191], v[48:51]
    ds_read_b128 v[136:139], v224 offset:4096
    v_mfma_f32_16x16x32_bf16 v[52:55], v[212:215], v[188:191], v[52:55]
    ds_read_b128 v[140:143], v224 offset:6144
    v_mfma_f32_16x16x32_bf16 v[56:59], v[216:219], v[188:191], v[56:59]
    ds_read_b128 v[144:147], v224 offset:8192
    v_mfma_f32_16x16x32_bf16 v[60:63], v[220:223], v[188:191], v[60:63]
    ds_read_b128 v[148:151], v224 offset:10240
    v_mfma_f32_16x16x32_bf16 v[64:67], v[208:211], v[192:195], v[64:67]
    ds_read_b128 v[152:155], v224 offset:12288
    v_mfma_f32_16x16x32_bf16 v[68:71], v[212:215], v[192:195], v[68:71]
    ds_read_b128 v[156:159], v224 offset:14336
    v_mfma_f32_16x16x32_bf16 v[72:75], v[216:219], v[192:195], v[72:75]
    v_mfma_f32_16x16x32_bf16 v[76:79], v[220:223], v[192:195], v[76:79]
    v_mfma_f32_16x16x32_bf16 v[80:83], v[208:211], v[196:199], v[80:83]
    v_mfma_f32_16x16x32_bf16 v[84:87], v[212:215], v[196:199], v[84:87]
    v_mfma_f32_16x16x32_bf16 v[88:91], v[216:219], v[196:199], v[88:91]
    v_mfma_f32_16x16x32_bf16 v[92:95], v[220:223], v[196:199], v[92:95]
    v_mfma_f32_16x16x32_bf16 v[96:99], v[208:211], v[200:203], v[96:99]
    v_mfma_f32_16x16x32_bf16 v[100:103], v[212:215], v[200:203], v[100:103]
    v_mfma_f32_16x16x32_bf16 v[104:107], v[216:219], v[200:203], v[104:107]
    v_mfma_f32_16x16x32_bf16 v[108:111], v[220:223], v[200:203], v[108:111]
    v_mfma_f32_16x16x32_bf16 v[112:115], v[208:211], v[204:207], v[112:115]
    v_mfma_f32_16x16x32_bf16 v[116:119], v[212:215], v[204:207], v[116:119]
    v_mfma_f32_16x16x32_bf16 v[120:123], v[216:219], v[204:207], v[120:123]
    v_mfma_f32_16x16x32_bf16 v[124:127], v[220:223], v[204:207], v[124:127]
    s_load_dwordx2 s[56:57], s[62:63], 0
    s_waitcnt lgkmcnt(13)
    v_mfma_f32_16x16x32_bf16 v[0:3], v[160:163], v[128:131], v[0:3]
    ds_read_b128 v[176:179], v225 offset:0
    s_waitcnt lgkmcnt(12)
    v_mfma_f32_16x16x32_bf16 v[4:7], v[164:167], v[128:131], v[4:7]
    ds_read_b64_tr_b16 v[208:209], v226 offset:8192
    s_waitcnt lgkmcnt(11)
    v_mfma_f32_16x16x32_bf16 v[8:11], v[168:171], v[128:131], v[8:11]
    ds_read_b64_tr_b16 v[210:211], v226 offset:9216
    s_waitcnt lgkmcnt(10)
    v_mfma_f32_16x16x32_bf16 v[12:15], v[172:175], v[128:131], v[12:15]
    ds_read_b64_tr_b16 v[212:213], v226 offset:24576
    s_waitcnt lgkmcnt(10)
    v_mfma_f32_16x16x32_bf16 v[16:19], v[160:163], v[132:135], v[16:19]
    ds_read_b64_tr_b16 v[214:215], v226 offset:25600
    v_mfma_f32_16x16x32_bf16 v[20:23], v[164:167], v[132:135], v[20:23]
    ds_read_b64_tr_b16 v[216:217], v227 offset:8192
    v_mfma_f32_16x16x32_bf16 v[24:27], v[168:171], v[132:135], v[24:27]
    ds_read_b64_tr_b16 v[218:219], v227 offset:9216
    v_mfma_f32_16x16x32_bf16 v[28:31], v[172:175], v[132:135], v[28:31]
    ds_read_b64_tr_b16 v[220:221], v227 offset:24576
    s_waitcnt lgkmcnt(13)
    v_mfma_f32_16x16x32_bf16 v[32:35], v[160:163], v[136:139], v[32:35]
    ds_read_b64_tr_b16 v[222:223], v227 offset:25600
    v_mfma_f32_16x16x32_bf16 v[36:39], v[164:167], v[136:139], v[36:39]
    ds_read_b128 v[180:183], v225 offset:2048
    v_mfma_f32_16x16x32_bf16 v[40:43], v[168:171], v[136:139], v[40:43]
    ds_read_b128 v[184:187], v225 offset:4096
    v_mfma_f32_16x16x32_bf16 v[44:47], v[172:175], v[136:139], v[44:47]
    ds_read_b128 v[188:191], v225 offset:6144
    s_waitcnt lgkmcnt(14)
    v_mfma_f32_16x16x32_bf16 v[48:51], v[160:163], v[140:143], v[48:51]
    ds_read_b128 v[192:195], v225 offset:8192
    v_mfma_f32_16x16x32_bf16 v[52:55], v[164:167], v[140:143], v[52:55]
    ds_read_b128 v[196:199], v225 offset:10240
    v_mfma_f32_16x16x32_bf16 v[56:59], v[168:171], v[140:143], v[56:59]
    ds_read_b128 v[200:203], v225 offset:12288
    v_mfma_f32_16x16x32_bf16 v[60:63], v[172:175], v[140:143], v[60:63]
    ds_read_b128 v[204:207], v225 offset:14336
    v_mfma_f32_16x16x32_bf16 v[64:67], v[160:163], v[144:147], v[64:67]
    v_mfma_f32_16x16x32_bf16 v[68:71], v[164:167], v[144:147], v[68:71]
    v_mfma_f32_16x16x32_bf16 v[72:75], v[168:171], v[144:147], v[72:75]
    v_mfma_f32_16x16x32_bf16 v[76:79], v[172:175], v[144:147], v[76:79]
    v_mfma_f32_16x16x32_bf16 v[80:83], v[160:163], v[148:151], v[80:83]
    v_mfma_f32_16x16x32_bf16 v[84:87], v[164:167], v[148:151], v[84:87]
    v_mfma_f32_16x16x32_bf16 v[88:91], v[168:171], v[148:151], v[88:91]
    v_mfma_f32_16x16x32_bf16 v[92:95], v[172:175], v[148:151], v[92:95]
    s_waitcnt lgkmcnt(14)
    v_mfma_f32_16x16x32_bf16 v[96:99], v[160:163], v[152:155], v[96:99]
    v_mfma_f32_16x16x32_bf16 v[100:103], v[164:167], v[152:155], v[100:103]
    v_mfma_f32_16x16x32_bf16 v[104:107], v[168:171], v[152:155], v[104:107]
    v_mfma_f32_16x16x32_bf16 v[108:111], v[172:175], v[152:155], v[108:111]
    v_mfma_f32_16x16x32_bf16 v[112:115], v[160:163], v[156:159], v[112:115]
    v_mfma_f32_16x16x32_bf16 v[116:119], v[164:167], v[156:159], v[116:119]
    v_mfma_f32_16x16x32_bf16 v[120:123], v[168:171], v[156:159], v[120:123]
    v_mfma_f32_16x16x32_bf16 v[124:127], v[172:175], v[156:159], v[124:127]
    s_waitcnt lgkmcnt(0)
    v_mfma_f32_16x16x32_bf16 v[0:3], v[208:211], v[176:179], v[0:3]
    v_add_u32 v224, 114688, v224
    v_add_u32 v225, 114688, v225
    v_mfma_f32_16x16x32_bf16 v[4:7], v[212:215], v[176:179], v[4:7]
    v_add_u32 v226, 114688, v226
    v_add_u32 v227, 114688, v227
    s_barrier
    v_mfma_f32_16x16x32_bf16 v[8:11], v[216:219], v[176:179], v[8:11]
    ds_read_b128 v[128:131], v224 offset:0
    v_mfma_f32_16x16x32_bf16 v[12:15], v[220:223], v[176:179], v[12:15]
    ds_read_b64_tr_b16 v[160:161], v226 offset:0
    v_mfma_f32_16x16x32_bf16 v[16:19], v[208:211], v[180:183], v[16:19]
    ds_read_b64_tr_b16 v[162:163], v226 offset:1024
    v_mfma_f32_16x16x32_bf16 v[20:23], v[212:215], v[180:183], v[20:23]
    ds_read_b64_tr_b16 v[164:165], v226 offset:16384
    v_mfma_f32_16x16x32_bf16 v[24:27], v[216:219], v[180:183], v[24:27]
    ds_read_b64_tr_b16 v[166:167], v226 offset:17408
    v_mfma_f32_16x16x32_bf16 v[28:31], v[220:223], v[180:183], v[28:31]
    ds_read_b64_tr_b16 v[168:169], v227 offset:0
    v_mfma_f32_16x16x32_bf16 v[32:35], v[208:211], v[184:187], v[32:35]
    ds_read_b64_tr_b16 v[170:171], v227 offset:1024
    v_mfma_f32_16x16x32_bf16 v[36:39], v[212:215], v[184:187], v[36:39]
    ds_read_b64_tr_b16 v[172:173], v227 offset:16384
    v_mfma_f32_16x16x32_bf16 v[40:43], v[216:219], v[184:187], v[40:43]
    ds_read_b64_tr_b16 v[174:175], v227 offset:17408
    v_mfma_f32_16x16x32_bf16 v[44:47], v[220:223], v[184:187], v[44:47]
    ds_read_b128 v[132:135], v224 offset:2048
    v_mfma_f32_16x16x32_bf16 v[48:51], v[208:211], v[188:191], v[48:51]
    ds_read_b128 v[136:139], v224 offset:4096
    v_mfma_f32_16x16x32_bf16 v[52:55], v[212:215], v[188:191], v[52:55]
    ds_read_b128 v[140:143], v224 offset:6144
    v_mfma_f32_16x16x32_bf16 v[56:59], v[216:219], v[188:191], v[56:59]
    ds_read_b128 v[144:147], v224 offset:8192
    v_mfma_f32_16x16x32_bf16 v[60:63], v[220:223], v[188:191], v[60:63]
    ds_read_b128 v[148:151], v224 offset:10240
    v_mfma_f32_16x16x32_bf16 v[64:67], v[208:211], v[192:195], v[64:67]
    ds_read_b128 v[152:155], v224 offset:12288
    v_mfma_f32_16x16x32_bf16 v[68:71], v[212:215], v[192:195], v[68:71]
    ds_read_b128 v[156:159], v224 offset:14336
    v_mfma_f32_16x16x32_bf16 v[72:75], v[216:219], v[192:195], v[72:75]
    v_mfma_f32_16x16x32_bf16 v[76:79], v[220:223], v[192:195], v[76:79]
    v_mfma_f32_16x16x32_bf16 v[80:83], v[208:211], v[196:199], v[80:83]
    v_mfma_f32_16x16x32_bf16 v[84:87], v[212:215], v[196:199], v[84:87]
    v_mfma_f32_16x16x32_bf16 v[88:91], v[216:219], v[196:199], v[88:91]
    v_mfma_f32_16x16x32_bf16 v[92:95], v[220:223], v[196:199], v[92:95]
    v_mfma_f32_16x16x32_bf16 v[96:99], v[208:211], v[200:203], v[96:99]
    v_mfma_f32_16x16x32_bf16 v[100:103], v[212:215], v[200:203], v[100:103]
    v_mfma_f32_16x16x32_bf16 v[104:107], v[216:219], v[200:203], v[104:107]
    v_mfma_f32_16x16x32_bf16 v[108:111], v[220:223], v[200:203], v[108:111]
    v_mfma_f32_16x16x32_bf16 v[112:115], v[208:211], v[204:207], v[112:115]
    v_mfma_f32_16x16x32_bf16 v[116:119], v[212:215], v[204:207], v[116:119]
    v_mfma_f32_16x16x32_bf16 v[120:123], v[216:219], v[204:207], v[120:123]
    v_mfma_f32_16x16x32_bf16 v[124:127], v[220:223], v[204:207], v[124:127]
    s_waitcnt lgkmcnt(13)
    v_mfma_f32_16x16x32_bf16 v[0:3], v[160:163], v[128:131], v[0:3]
    ds_read_b128 v[176:179], v225 offset:0
    s_waitcnt lgkmcnt(12)
    v_mfma_f32_16x16x32_bf16 v[4:7], v[164:167], v[128:131], v[4:7]
    ds_read_b64_tr_b16 v[208:209], v226 offset:8192
    s_waitcnt lgkmcnt(11)
    v_mfma_f32_16x16x32_bf16 v[8:11], v[168:171], v[128:131], v[8:11]
    ds_read_b64_tr_b16 v[210:211], v226 offset:9216
    s_waitcnt lgkmcnt(10)
    v_mfma_f32_16x16x32_bf16 v[12:15], v[172:175], v[128:131], v[12:15]
    ds_read_b64_tr_b16 v[212:213], v226 offset:24576
    s_waitcnt lgkmcnt(10)
    v_mfma_f32_16x16x32_bf16 v[16:19], v[160:163], v[132:135], v[16:19]
    ds_read_b64_tr_b16 v[214:215], v226 offset:25600
    v_mfma_f32_16x16x32_bf16 v[20:23], v[164:167], v[132:135], v[20:23]
    ds_read_b64_tr_b16 v[216:217], v227 offset:8192
    v_mfma_f32_16x16x32_bf16 v[24:27], v[168:171], v[132:135], v[24:27]
    ds_read_b64_tr_b16 v[218:219], v227 offset:9216
    v_mfma_f32_16x16x32_bf16 v[28:31], v[172:175], v[132:135], v[28:31]
    ds_read_b64_tr_b16 v[220:221], v227 offset:24576
    s_waitcnt lgkmcnt(13)
    v_mfma_f32_16x16x32_bf16 v[32:35], v[160:163], v[136:139], v[32:35]
    ds_read_b64_tr_b16 v[222:223], v227 offset:25600
    v_mfma_f32_16x16x32_bf16 v[36:39], v[164:167], v[136:139], v[36:39]
    ds_read_b128 v[180:183], v225 offset:2048
    v_mfma_f32_16x16x32_bf16 v[40:43], v[168:171], v[136:139], v[40:43]
    ds_read_b128 v[184:187], v225 offset:4096
    v_mfma_f32_16x16x32_bf16 v[44:47], v[172:175], v[136:139], v[44:47]
    ds_read_b128 v[188:191], v225 offset:6144
    s_waitcnt lgkmcnt(14)
    v_mfma_f32_16x16x32_bf16 v[48:51], v[160:163], v[140:143], v[48:51]
    ds_read_b128 v[192:195], v225 offset:8192
    v_mfma_f32_16x16x32_bf16 v[52:55], v[164:167], v[140:143], v[52:55]
    ds_read_b128 v[196:199], v225 offset:10240
    v_mfma_f32_16x16x32_bf16 v[56:59], v[168:171], v[140:143], v[56:59]
    ds_read_b128 v[200:203], v225 offset:12288
    v_mfma_f32_16x16x32_bf16 v[60:63], v[172:175], v[140:143], v[60:63]
    ds_read_b128 v[204:207], v225 offset:14336
    v_mfma_f32_16x16x32_bf16 v[64:67], v[160:163], v[144:147], v[64:67]
    v_mfma_f32_16x16x32_bf16 v[68:71], v[164:167], v[144:147], v[68:71]
    v_mfma_f32_16x16x32_bf16 v[72:75], v[168:171], v[144:147], v[72:75]
    v_mfma_f32_16x16x32_bf16 v[76:79], v[172:175], v[144:147], v[76:79]
    v_mfma_f32_16x16x32_bf16 v[80:83], v[160:163], v[148:151], v[80:83]
    v_mfma_f32_16x16x32_bf16 v[84:87], v[164:167], v[148:151], v[84:87]
    v_mfma_f32_16x16x32_bf16 v[88:91], v[168:171], v[148:151], v[88:91]
    v_mfma_f32_16x16x32_bf16 v[92:95], v[172:175], v[148:151], v[92:95]
    s_waitcnt lgkmcnt(14)
    v_mfma_f32_16x16x32_bf16 v[96:99], v[160:163], v[152:155], v[96:99]
    v_mfma_f32_16x16x32_bf16 v[100:103], v[164:167], v[152:155], v[100:103]
    v_mfma_f32_16x16x32_bf16 v[104:107], v[168:171], v[152:155], v[104:107]
    v_mfma_f32_16x16x32_bf16 v[108:111], v[172:175], v[152:155], v[108:111]
    v_mfma_f32_16x16x32_bf16 v[112:115], v[160:163], v[156:159], v[112:115]
    v_mfma_f32_16x16x32_bf16 v[116:119], v[164:167], v[156:159], v[116:119]
    v_mfma_f32_16x16x32_bf16 v[120:123], v[168:171], v[156:159], v[120:123]
    v_mfma_f32_16x16x32_bf16 v[124:127], v[172:175], v[156:159], v[124:127]
    s_waitcnt lgkmcnt(0)
    v_mfma_f32_16x16x32_bf16 v[0:3], v[208:211], v[176:179], v[0:3]
    v_add_u32 v224, 4294901760, v224
    v_add_u32 v225, 4294901760, v225
    v_mfma_f32_16x16x32_bf16 v[4:7], v[212:215], v[176:179], v[4:7]
    v_add_u32 v226, 4294901760, v226
    v_add_u32 v227, 4294901760, v227
    s_barrier
    v_mfma_f32_16x16x32_bf16 v[8:11], v[216:219], v[176:179], v[8:11]
    ds_read_b128 v[128:131], v224 offset:0
    v_mfma_f32_16x16x32_bf16 v[12:15], v[220:223], v[176:179], v[12:15]
    ds_read_b64_tr_b16 v[160:161], v226 offset:0
    v_mfma_f32_16x16x32_bf16 v[16:19], v[208:211], v[180:183], v[16:19]
    ds_read_b64_tr_b16 v[162:163], v226 offset:1024
    v_mfma_f32_16x16x32_bf16 v[20:23], v[212:215], v[180:183], v[20:23]
    ds_read_b64_tr_b16 v[164:165], v226 offset:16384
    v_mfma_f32_16x16x32_bf16 v[24:27], v[216:219], v[180:183], v[24:27]
    ds_read_b64_tr_b16 v[166:167], v226 offset:17408
    v_mfma_f32_16x16x32_bf16 v[28:31], v[220:223], v[180:183], v[28:31]
    ds_read_b64_tr_b16 v[168:169], v227 offset:0
    v_mfma_f32_16x16x32_bf16 v[32:35], v[208:211], v[184:187], v[32:35]
    ds_read_b64_tr_b16 v[170:171], v227 offset:1024
    v_mfma_f32_16x16x32_bf16 v[36:39], v[212:215], v[184:187], v[36:39]
    ds_read_b64_tr_b16 v[172:173], v227 offset:16384
    v_mfma_f32_16x16x32_bf16 v[40:43], v[216:219], v[184:187], v[40:43]
    ds_read_b64_tr_b16 v[174:175], v227 offset:17408
    v_mfma_f32_16x16x32_bf16 v[44:47], v[220:223], v[184:187], v[44:47]
    ds_read_b128 v[132:135], v224 offset:2048
    v_mfma_f32_16x16x32_bf16 v[48:51], v[208:211], v[188:191], v[48:51]
    ds_read_b128 v[136:139], v224 offset:4096
    v_mfma_f32_16x16x32_bf16 v[52:55], v[212:215], v[188:191], v[52:55]
    ds_read_b128 v[140:143], v224 offset:6144
    v_mfma_f32_16x16x32_bf16 v[56:59], v[216:219], v[188:191], v[56:59]
    ds_read_b128 v[144:147], v224 offset:8192
    v_mfma_f32_16x16x32_bf16 v[60:63], v[220:223], v[188:191], v[60:63]
    ds_read_b128 v[148:151], v224 offset:10240
    v_mfma_f32_16x16x32_bf16 v[64:67], v[208:211], v[192:195], v[64:67]
    ds_read_b128 v[152:155], v224 offset:12288
    v_mfma_f32_16x16x32_bf16 v[68:71], v[212:215], v[192:195], v[68:71]
    ds_read_b128 v[156:159], v224 offset:14336
    v_mfma_f32_16x16x32_bf16 v[72:75], v[216:219], v[192:195], v[72:75]
    v_mfma_f32_16x16x32_bf16 v[76:79], v[220:223], v[192:195], v[76:79]
    v_mfma_f32_16x16x32_bf16 v[80:83], v[208:211], v[196:199], v[80:83]
    v_mfma_f32_16x16x32_bf16 v[84:87], v[212:215], v[196:199], v[84:87]
    v_mfma_f32_16x16x32_bf16 v[88:91], v[216:219], v[196:199], v[88:91]
    v_mfma_f32_16x16x32_bf16 v[92:95], v[220:223], v[196:199], v[92:95]
    v_mfma_f32_16x16x32_bf16 v[96:99], v[208:211], v[200:203], v[96:99]
    v_mfma_f32_16x16x32_bf16 v[100:103], v[212:215], v[200:203], v[100:103]
    v_mfma_f32_16x16x32_bf16 v[104:107], v[216:219], v[200:203], v[104:107]
    v_mfma_f32_16x16x32_bf16 v[108:111], v[220:223], v[200:203], v[108:111]
    v_mfma_f32_16x16x32_bf16 v[112:115], v[208:211], v[204:207], v[112:115]
    v_mfma_f32_16x16x32_bf16 v[116:119], v[212:215], v[204:207], v[116:119]
    v_mfma_f32_16x16x32_bf16 v[120:123], v[216:219], v[204:207], v[120:123]
    v_mfma_f32_16x16x32_bf16 v[124:127], v[220:223], v[204:207], v[124:127]
    s_waitcnt lgkmcnt(13)
    v_mfma_f32_16x16x32_bf16 v[0:3], v[160:163], v[128:131], v[0:3]
    ds_read_b128 v[176:179], v225 offset:0
    s_waitcnt lgkmcnt(12)
    v_mfma_f32_16x16x32_bf16 v[4:7], v[164:167], v[128:131], v[4:7]
    ds_read_b64_tr_b16 v[208:209], v226 offset:8192
    s_waitcnt lgkmcnt(11)
    v_mfma_f32_16x16x32_bf16 v[8:11], v[168:171], v[128:131], v[8:11]
    ds_read_b64_tr_b16 v[210:211], v226 offset:9216
    s_waitcnt lgkmcnt(10)
    v_mfma_f32_16x16x32_bf16 v[12:15], v[172:175], v[128:131], v[12:15]
    ds_read_b64_tr_b16 v[212:213], v226 offset:24576
    s_waitcnt lgkmcnt(10)
    v_mfma_f32_16x16x32_bf16 v[16:19], v[160:163], v[132:135], v[16:19]
    ds_read_b64_tr_b16 v[214:215], v226 offset:25600
    v_mfma_f32_16x16x32_bf16 v[20:23], v[164:167], v[132:135], v[20:23]
    ds_read_b64_tr_b16 v[216:217], v227 offset:8192
    v_mfma_f32_16x16x32_bf16 v[24:27], v[168:171], v[132:135], v[24:27]
    ds_read_b64_tr_b16 v[218:219], v227 offset:9216
    v_mfma_f32_16x16x32_bf16 v[28:31], v[172:175], v[132:135], v[28:31]
    ds_read_b64_tr_b16 v[220:221], v227 offset:24576
    s_waitcnt lgkmcnt(13)
    v_mfma_f32_16x16x32_bf16 v[32:35], v[160:163], v[136:139], v[32:35]
    ds_read_b64_tr_b16 v[222:223], v227 offset:25600
    v_mfma_f32_16x16x32_bf16 v[36:39], v[164:167], v[136:139], v[36:39]
    ds_read_b128 v[180:183], v225 offset:2048
    v_mfma_f32_16x16x32_bf16 v[40:43], v[168:171], v[136:139], v[40:43]
    ds_read_b128 v[184:187], v225 offset:4096
    v_mfma_f32_16x16x32_bf16 v[44:47], v[172:175], v[136:139], v[44:47]
    ds_read_b128 v[188:191], v225 offset:6144
    s_waitcnt lgkmcnt(14)
    v_mfma_f32_16x16x32_bf16 v[48:51], v[160:163], v[140:143], v[48:51]
    ds_read_b128 v[192:195], v225 offset:8192
    v_mfma_f32_16x16x32_bf16 v[52:55], v[164:167], v[140:143], v[52:55]
    ds_read_b128 v[196:199], v225 offset:10240
    v_mfma_f32_16x16x32_bf16 v[56:59], v[168:171], v[140:143], v[56:59]
    ds_read_b128 v[200:203], v225 offset:12288
    v_mfma_f32_16x16x32_bf16 v[60:63], v[172:175], v[140:143], v[60:63]
    ds_read_b128 v[204:207], v225 offset:14336
    v_mfma_f32_16x16x32_bf16 v[64:67], v[160:163], v[144:147], v[64:67]
    v_mfma_f32_16x16x32_bf16 v[68:71], v[164:167], v[144:147], v[68:71]
    v_mfma_f32_16x16x32_bf16 v[72:75], v[168:171], v[144:147], v[72:75]
    v_mfma_f32_16x16x32_bf16 v[76:79], v[172:175], v[144:147], v[76:79]
    v_mfma_f32_16x16x32_bf16 v[80:83], v[160:163], v[148:151], v[80:83]
    v_mfma_f32_16x16x32_bf16 v[84:87], v[164:167], v[148:151], v[84:87]
    v_mfma_f32_16x16x32_bf16 v[88:91], v[168:171], v[148:151], v[88:91]
    v_mfma_f32_16x16x32_bf16 v[92:95], v[172:175], v[148:151], v[92:95]
    s_waitcnt lgkmcnt(14)
    v_mfma_f32_16x16x32_bf16 v[96:99], v[160:163], v[152:155], v[96:99]
    v_mfma_f32_16x16x32_bf16 v[100:103], v[164:167], v[152:155], v[100:103]
    v_mfma_f32_16x16x32_bf16 v[104:107], v[168:171], v[152:155], v[104:107]
    v_mfma_f32_16x16x32_bf16 v[108:111], v[172:175], v[152:155], v[108:111]
    v_mfma_f32_16x16x32_bf16 v[112:115], v[160:163], v[156:159], v[112:115]
    v_mfma_f32_16x16x32_bf16 v[116:119], v[164:167], v[156:159], v[116:119]
    v_mfma_f32_16x16x32_bf16 v[120:123], v[168:171], v[156:159], v[120:123]
    v_mfma_f32_16x16x32_bf16 v[124:127], v[172:175], v[156:159], v[124:127]
    s_waitcnt lgkmcnt(0)
    v_mfma_f32_16x16x32_bf16 v[0:3], v[208:211], v[176:179], v[0:3]
    v_add_u32 v224, 4294918144, v224
    v_add_u32 v225, 4294918144, v225
    v_mfma_f32_16x16x32_bf16 v[4:7], v[212:215], v[176:179], v[4:7]
    v_add_u32 v226, 4294918144, v226
    v_add_u32 v227, 4294918144, v227
    s_barrier
    v_mfma_f32_16x16x32_bf16 v[8:11], v[216:219], v[176:179], v[8:11]
    ds_read_b128 v[128:131], v224 offset:0
    v_mfma_f32_16x16x32_bf16 v[12:15], v[220:223], v[176:179], v[12:15]
    ds_read_b64_tr_b16 v[160:161], v226 offset:0
    v_mfma_f32_16x16x32_bf16 v[16:19], v[208:211], v[180:183], v[16:19]
    ds_read_b64_tr_b16 v[162:163], v226 offset:1024
    v_mfma_f32_16x16x32_bf16 v[20:23], v[212:215], v[180:183], v[20:23]
    ds_read_b64_tr_b16 v[164:165], v226 offset:16384
    v_mfma_f32_16x16x32_bf16 v[24:27], v[216:219], v[180:183], v[24:27]
    ds_read_b64_tr_b16 v[166:167], v226 offset:17408
    v_mfma_f32_16x16x32_bf16 v[28:31], v[220:223], v[180:183], v[28:31]
    ds_read_b64_tr_b16 v[168:169], v227 offset:0
    v_mfma_f32_16x16x32_bf16 v[32:35], v[208:211], v[184:187], v[32:35]
    ds_read_b64_tr_b16 v[170:171], v227 offset:1024
    v_mfma_f32_16x16x32_bf16 v[36:39], v[212:215], v[184:187], v[36:39]
    ds_read_b64_tr_b16 v[172:173], v227 offset:16384
    v_mfma_f32_16x16x32_bf16 v[40:43], v[216:219], v[184:187], v[40:43]
    ds_read_b64_tr_b16 v[174:175], v227 offset:17408
    v_mfma_f32_16x16x32_bf16 v[44:47], v[220:223], v[184:187], v[44:47]
    ds_read_b128 v[132:135], v224 offset:2048
    v_mfma_f32_16x16x32_bf16 v[48:51], v[208:211], v[188:191], v[48:51]
    ds_read_b128 v[136:139], v224 offset:4096
    v_mfma_f32_16x16x32_bf16 v[52:55], v[212:215], v[188:191], v[52:55]
    ds_read_b128 v[140:143], v224 offset:6144
    v_mfma_f32_16x16x32_bf16 v[56:59], v[216:219], v[188:191], v[56:59]
    ds_read_b128 v[144:147], v224 offset:8192
    v_mfma_f32_16x16x32_bf16 v[60:63], v[220:223], v[188:191], v[60:63]
    ds_read_b128 v[148:151], v224 offset:10240
    v_mfma_f32_16x16x32_bf16 v[64:67], v[208:211], v[192:195], v[64:67]
    ds_read_b128 v[152:155], v224 offset:12288
    v_mfma_f32_16x16x32_bf16 v[68:71], v[212:215], v[192:195], v[68:71]
    ds_read_b128 v[156:159], v224 offset:14336
    v_mfma_f32_16x16x32_bf16 v[72:75], v[216:219], v[192:195], v[72:75]
    v_mfma_f32_16x16x32_bf16 v[76:79], v[220:223], v[192:195], v[76:79]
    v_mfma_f32_16x16x32_bf16 v[80:83], v[208:211], v[196:199], v[80:83]
    v_mfma_f32_16x16x32_bf16 v[84:87], v[212:215], v[196:199], v[84:87]
    v_mfma_f32_16x16x32_bf16 v[88:91], v[216:219], v[196:199], v[88:91]
    v_mfma_f32_16x16x32_bf16 v[92:95], v[220:223], v[196:199], v[92:95]
    v_mfma_f32_16x16x32_bf16 v[96:99], v[208:211], v[200:203], v[96:99]
    v_mfma_f32_16x16x32_bf16 v[100:103], v[212:215], v[200:203], v[100:103]
    v_mfma_f32_16x16x32_bf16 v[104:107], v[216:219], v[200:203], v[104:107]
    v_mfma_f32_16x16x32_bf16 v[108:111], v[220:223], v[200:203], v[108:111]
    v_mfma_f32_16x16x32_bf16 v[112:115], v[208:211], v[204:207], v[112:115]
    v_mfma_f32_16x16x32_bf16 v[116:119], v[212:215], v[204:207], v[116:119]
    v_mfma_f32_16x16x32_bf16 v[120:123], v[216:219], v[204:207], v[120:123]
    v_mfma_f32_16x16x32_bf16 v[124:127], v[220:223], v[204:207], v[124:127]
    s_waitcnt lgkmcnt(13)
    v_mfma_f32_16x16x32_bf16 v[0:3], v[160:163], v[128:131], v[0:3]
    ds_read_b128 v[176:179], v225 offset:0
    s_waitcnt lgkmcnt(12)
    v_mfma_f32_16x16x32_bf16 v[4:7], v[164:167], v[128:131], v[4:7]
    ds_read_b64_tr_b16 v[208:209], v226 offset:8192
    s_waitcnt lgkmcnt(11)
    v_mfma_f32_16x16x32_bf16 v[8:11], v[168:171], v[128:131], v[8:11]
    ds_read_b64_tr_b16 v[210:211], v226 offset:9216
    s_waitcnt lgkmcnt(10)
    v_mfma_f32_16x16x32_bf16 v[12:15], v[172:175], v[128:131], v[12:15]
    ds_read_b64_tr_b16 v[212:213], v226 offset:24576
    s_waitcnt lgkmcnt(10)
    v_mfma_f32_16x16x32_bf16 v[16:19], v[160:163], v[132:135], v[16:19]
    ds_read_b64_tr_b16 v[214:215], v226 offset:25600
    v_mfma_f32_16x16x32_bf16 v[20:23], v[164:167], v[132:135], v[20:23]
    ds_read_b64_tr_b16 v[216:217], v227 offset:8192
    v_mfma_f32_16x16x32_bf16 v[24:27], v[168:171], v[132:135], v[24:27]
    ds_read_b64_tr_b16 v[218:219], v227 offset:9216
    v_mfma_f32_16x16x32_bf16 v[28:31], v[172:175], v[132:135], v[28:31]
    ds_read_b64_tr_b16 v[220:221], v227 offset:24576
    s_waitcnt lgkmcnt(13)
    v_mfma_f32_16x16x32_bf16 v[32:35], v[160:163], v[136:139], v[32:35]
    ds_read_b64_tr_b16 v[222:223], v227 offset:25600
    v_mfma_f32_16x16x32_bf16 v[36:39], v[164:167], v[136:139], v[36:39]
    ds_read_b128 v[180:183], v225 offset:2048
    v_mfma_f32_16x16x32_bf16 v[40:43], v[168:171], v[136:139], v[40:43]
    ds_read_b128 v[184:187], v225 offset:4096
    v_mfma_f32_16x16x32_bf16 v[44:47], v[172:175], v[136:139], v[44:47]
    ds_read_b128 v[188:191], v225 offset:6144
    s_waitcnt lgkmcnt(14)
    v_mfma_f32_16x16x32_bf16 v[48:51], v[160:163], v[140:143], v[48:51]
    ds_read_b128 v[192:195], v225 offset:8192
    v_mfma_f32_16x16x32_bf16 v[52:55], v[164:167], v[140:143], v[52:55]
    ds_read_b128 v[196:199], v225 offset:10240
    v_mfma_f32_16x16x32_bf16 v[56:59], v[168:171], v[140:143], v[56:59]
    ds_read_b128 v[200:203], v225 offset:12288
    v_mfma_f32_16x16x32_bf16 v[60:63], v[172:175], v[140:143], v[60:63]
    ds_read_b128 v[204:207], v225 offset:14336
    v_mfma_f32_16x16x32_bf16 v[64:67], v[160:163], v[144:147], v[64:67]
    v_mfma_f32_16x16x32_bf16 v[68:71], v[164:167], v[144:147], v[68:71]
    v_mfma_f32_16x16x32_bf16 v[72:75], v[168:171], v[144:147], v[72:75]
    v_mfma_f32_16x16x32_bf16 v[76:79], v[172:175], v[144:147], v[76:79]
    v_mfma_f32_16x16x32_bf16 v[80:83], v[160:163], v[148:151], v[80:83]
    v_mfma_f32_16x16x32_bf16 v[84:87], v[164:167], v[148:151], v[84:87]
    v_mfma_f32_16x16x32_bf16 v[88:91], v[168:171], v[148:151], v[88:91]
    v_mfma_f32_16x16x32_bf16 v[92:95], v[172:175], v[148:151], v[92:95]
    s_waitcnt lgkmcnt(14)
    v_mfma_f32_16x16x32_bf16 v[96:99], v[160:163], v[152:155], v[96:99]
    v_mfma_f32_16x16x32_bf16 v[100:103], v[164:167], v[152:155], v[100:103]
    v_mfma_f32_16x16x32_bf16 v[104:107], v[168:171], v[152:155], v[104:107]
    v_mfma_f32_16x16x32_bf16 v[108:111], v[172:175], v[152:155], v[108:111]
    v_mfma_f32_16x16x32_bf16 v[112:115], v[160:163], v[156:159], v[112:115]
    v_mfma_f32_16x16x32_bf16 v[116:119], v[164:167], v[156:159], v[116:119]
    v_mfma_f32_16x16x32_bf16 v[120:123], v[168:171], v[156:159], v[120:123]
    v_mfma_f32_16x16x32_bf16 v[124:127], v[172:175], v[156:159], v[124:127]
    s_waitcnt lgkmcnt(0)
    v_mfma_f32_16x16x32_bf16 v[0:3], v[208:211], v[176:179], v[0:3]
    v_add_u32 v224, 114688, v224
    v_add_u32 v225, 114688, v225
    v_mfma_f32_16x16x32_bf16 v[4:7], v[212:215], v[176:179], v[4:7]
    v_add_u32 v226, 114688, v226
    v_add_u32 v227, 114688, v227
    s_barrier
    v_mfma_f32_16x16x32_bf16 v[8:11], v[216:219], v[176:179], v[8:11]
    ds_read_b128 v[128:131], v224 offset:0
    v_mfma_f32_16x16x32_bf16 v[12:15], v[220:223], v[176:179], v[12:15]
    ds_read_b64_tr_b16 v[160:161], v226 offset:0
    v_mfma_f32_16x16x32_bf16 v[16:19], v[208:211], v[180:183], v[16:19]
    ds_read_b64_tr_b16 v[162:163], v226 offset:1024
    v_mfma_f32_16x16x32_bf16 v[20:23], v[212:215], v[180:183], v[20:23]
    ds_read_b64_tr_b16 v[164:165], v226 offset:16384
    v_mfma_f32_16x16x32_bf16 v[24:27], v[216:219], v[180:183], v[24:27]
    ds_read_b64_tr_b16 v[166:167], v226 offset:17408
    v_mfma_f32_16x16x32_bf16 v[28:31], v[220:223], v[180:183], v[28:31]
    ds_read_b64_tr_b16 v[168:169], v227 offset:0
    v_mfma_f32_16x16x32_bf16 v[32:35], v[208:211], v[184:187], v[32:35]
    ds_read_b64_tr_b16 v[170:171], v227 offset:1024
    v_mfma_f32_16x16x32_bf16 v[36:39], v[212:215], v[184:187], v[36:39]
    ds_read_b64_tr_b16 v[172:173], v227 offset:16384
    v_mfma_f32_16x16x32_bf16 v[40:43], v[216:219], v[184:187], v[40:43]
    ds_read_b64_tr_b16 v[174:175], v227 offset:17408
    v_mfma_f32_16x16x32_bf16 v[44:47], v[220:223], v[184:187], v[44:47]
    ds_read_b128 v[132:135], v224 offset:2048
    v_mfma_f32_16x16x32_bf16 v[48:51], v[208:211], v[188:191], v[48:51]
    ds_read_b128 v[136:139], v224 offset:4096
    v_mfma_f32_16x16x32_bf16 v[52:55], v[212:215], v[188:191], v[52:55]
    ds_read_b128 v[140:143], v224 offset:6144
    v_mfma_f32_16x16x32_bf16 v[56:59], v[216:219], v[188:191], v[56:59]
    ds_read_b128 v[144:147], v224 offset:8192
    v_mfma_f32_16x16x32_bf16 v[60:63], v[220:223], v[188:191], v[60:63]
    ds_read_b128 v[148:151], v224 offset:10240
    v_mfma_f32_16x16x32_bf16 v[64:67], v[208:211], v[192:195], v[64:67]
    ds_read_b128 v[152:155], v224 offset:12288
    v_mfma_f32_16x16x32_bf16 v[68:71], v[212:215], v[192:195], v[68:71]
    ds_read_b128 v[156:159], v224 offset:14336
    v_mfma_f32_16x16x32_bf16 v[72:75], v[216:219], v[192:195], v[72:75]
    v_mfma_f32_16x16x32_bf16 v[76:79], v[220:223], v[192:195], v[76:79]
    v_mfma_f32_16x16x32_bf16 v[80:83], v[208:211], v[196:199], v[80:83]
    v_mfma_f32_16x16x32_bf16 v[84:87], v[212:215], v[196:199], v[84:87]
    v_mfma_f32_16x16x32_bf16 v[88:91], v[216:219], v[196:199], v[88:91]
    v_mfma_f32_16x16x32_bf16 v[92:95], v[220:223], v[196:199], v[92:95]
    v_mfma_f32_16x16x32_bf16 v[96:99], v[208:211], v[200:203], v[96:99]
    v_mfma_f32_16x16x32_bf16 v[100:103], v[212:215], v[200:203], v[100:103]
    v_mfma_f32_16x16x32_bf16 v[104:107], v[216:219], v[200:203], v[104:107]
    v_mfma_f32_16x16x32_bf16 v[108:111], v[220:223], v[200:203], v[108:111]
    v_mfma_f32_16x16x32_bf16 v[112:115], v[208:211], v[204:207], v[112:115]
    v_mfma_f32_16x16x32_bf16 v[116:119], v[212:215], v[204:207], v[116:119]
    v_mfma_f32_16x16x32_bf16 v[120:123], v[216:219], v[204:207], v[120:123]
    v_mfma_f32_16x16x32_bf16 v[124:127], v[220:223], v[204:207], v[124:127]
    s_waitcnt lgkmcnt(13)
    v_mfma_f32_16x16x32_bf16 v[0:3], v[160:163], v[128:131], v[0:3]
    ds_read_b128 v[176:179], v225 offset:0
    s_waitcnt lgkmcnt(12)
    v_mfma_f32_16x16x32_bf16 v[4:7], v[164:167], v[128:131], v[4:7]
    ds_read_b64_tr_b16 v[208:209], v226 offset:8192
    s_waitcnt lgkmcnt(11)
    v_mfma_f32_16x16x32_bf16 v[8:11], v[168:171], v[128:131], v[8:11]
    ds_read_b64_tr_b16 v[210:211], v226 offset:9216
    s_waitcnt lgkmcnt(10)
    v_mfma_f32_16x16x32_bf16 v[12:15], v[172:175], v[128:131], v[12:15]
    ds_read_b64_tr_b16 v[212:213], v226 offset:24576
    s_waitcnt lgkmcnt(10)
    v_mfma_f32_16x16x32_bf16 v[16:19], v[160:163], v[132:135], v[16:19]
    ds_read_b64_tr_b16 v[214:215], v226 offset:25600
    v_mfma_f32_16x16x32_bf16 v[20:23], v[164:167], v[132:135], v[20:23]
    ds_read_b64_tr_b16 v[216:217], v227 offset:8192
    v_mfma_f32_16x16x32_bf16 v[24:27], v[168:171], v[132:135], v[24:27]
    ds_read_b64_tr_b16 v[218:219], v227 offset:9216
    v_mfma_f32_16x16x32_bf16 v[28:31], v[172:175], v[132:135], v[28:31]
    ds_read_b64_tr_b16 v[220:221], v227 offset:24576
    s_waitcnt lgkmcnt(13)
    v_mfma_f32_16x16x32_bf16 v[32:35], v[160:163], v[136:139], v[32:35]
    ds_read_b64_tr_b16 v[222:223], v227 offset:25600
    v_mfma_f32_16x16x32_bf16 v[36:39], v[164:167], v[136:139], v[36:39]
    ds_read_b128 v[180:183], v225 offset:2048
    v_mfma_f32_16x16x32_bf16 v[40:43], v[168:171], v[136:139], v[40:43]
    ds_read_b128 v[184:187], v225 offset:4096
    v_mfma_f32_16x16x32_bf16 v[44:47], v[172:175], v[136:139], v[44:47]
    ds_read_b128 v[188:191], v225 offset:6144
    s_waitcnt lgkmcnt(14)
    v_mfma_f32_16x16x32_bf16 v[48:51], v[160:163], v[140:143], v[48:51]
    ds_read_b128 v[192:195], v225 offset:8192
    v_mfma_f32_16x16x32_bf16 v[52:55], v[164:167], v[140:143], v[52:55]
    ds_read_b128 v[196:199], v225 offset:10240
    v_mfma_f32_16x16x32_bf16 v[56:59], v[168:171], v[140:143], v[56:59]
    ds_read_b128 v[200:203], v225 offset:12288
    v_mfma_f32_16x16x32_bf16 v[60:63], v[172:175], v[140:143], v[60:63]
    ds_read_b128 v[204:207], v225 offset:14336
    v_mfma_f32_16x16x32_bf16 v[64:67], v[160:163], v[144:147], v[64:67]
    v_mfma_f32_16x16x32_bf16 v[68:71], v[164:167], v[144:147], v[68:71]
    v_mfma_f32_16x16x32_bf16 v[72:75], v[168:171], v[144:147], v[72:75]
    v_mfma_f32_16x16x32_bf16 v[76:79], v[172:175], v[144:147], v[76:79]
    v_mfma_f32_16x16x32_bf16 v[80:83], v[160:163], v[148:151], v[80:83]
    v_mfma_f32_16x16x32_bf16 v[84:87], v[164:167], v[148:151], v[84:87]
    v_mfma_f32_16x16x32_bf16 v[88:91], v[168:171], v[148:151], v[88:91]
    v_mfma_f32_16x16x32_bf16 v[92:95], v[172:175], v[148:151], v[92:95]
    s_waitcnt lgkmcnt(14)
    v_mfma_f32_16x16x32_bf16 v[96:99], v[160:163], v[152:155], v[96:99]
    v_mfma_f32_16x16x32_bf16 v[100:103], v[164:167], v[152:155], v[100:103]
    v_mfma_f32_16x16x32_bf16 v[104:107], v[168:171], v[152:155], v[104:107]
    v_mfma_f32_16x16x32_bf16 v[108:111], v[172:175], v[152:155], v[108:111]
    v_mfma_f32_16x16x32_bf16 v[112:115], v[160:163], v[156:159], v[112:115]
    v_mfma_f32_16x16x32_bf16 v[116:119], v[164:167], v[156:159], v[116:119]
    v_mfma_f32_16x16x32_bf16 v[120:123], v[168:171], v[156:159], v[120:123]
    v_mfma_f32_16x16x32_bf16 v[124:127], v[172:175], v[156:159], v[124:127]
    s_waitcnt lgkmcnt(0)
    v_mfma_f32_16x16x32_bf16 v[0:3], v[208:211], v[176:179], v[0:3]
    v_add_u32 v224, 4294901760, v224
    v_add_u32 v225, 4294901760, v225
    v_mfma_f32_16x16x32_bf16 v[4:7], v[212:215], v[176:179], v[4:7]
    v_add_u32 v226, 4294901760, v226
    v_add_u32 v227, 4294901760, v227
    s_barrier
    v_mfma_f32_16x16x32_bf16 v[8:11], v[216:219], v[176:179], v[8:11]
    ds_read_b128 v[128:131], v224 offset:0
    v_mfma_f32_16x16x32_bf16 v[12:15], v[220:223], v[176:179], v[12:15]
    ds_read_b64_tr_b16 v[160:161], v226 offset:0
    v_mfma_f32_16x16x32_bf16 v[16:19], v[208:211], v[180:183], v[16:19]
    ds_read_b64_tr_b16 v[162:163], v226 offset:1024
    v_mfma_f32_16x16x32_bf16 v[20:23], v[212:215], v[180:183], v[20:23]
    ds_read_b64_tr_b16 v[164:165], v226 offset:16384
    v_mfma_f32_16x16x32_bf16 v[24:27], v[216:219], v[180:183], v[24:27]
    ds_read_b64_tr_b16 v[166:167], v226 offset:17408
    v_mfma_f32_16x16x32_bf16 v[28:31], v[220:223], v[180:183], v[28:31]
    ds_read_b64_tr_b16 v[168:169], v227 offset:0
    v_mfma_f32_16x16x32_bf16 v[32:35], v[208:211], v[184:187], v[32:35]
    ds_read_b64_tr_b16 v[170:171], v227 offset:1024
    v_mfma_f32_16x16x32_bf16 v[36:39], v[212:215], v[184:187], v[36:39]
    ds_read_b64_tr_b16 v[172:173], v227 offset:16384
    v_mfma_f32_16x16x32_bf16 v[40:43], v[216:219], v[184:187], v[40:43]
    ds_read_b64_tr_b16 v[174:175], v227 offset:17408
    v_mfma_f32_16x16x32_bf16 v[44:47], v[220:223], v[184:187], v[44:47]
    ds_read_b128 v[132:135], v224 offset:2048
    v_mfma_f32_16x16x32_bf16 v[48:51], v[208:211], v[188:191], v[48:51]
    ds_read_b128 v[136:139], v224 offset:4096
    v_mfma_f32_16x16x32_bf16 v[52:55], v[212:215], v[188:191], v[52:55]
    ds_read_b128 v[140:143], v224 offset:6144
    v_mfma_f32_16x16x32_bf16 v[56:59], v[216:219], v[188:191], v[56:59]
    v_mfma_f32_16x16x32_bf16 v[60:63], v[220:223], v[188:191], v[60:63]
    v_mfma_f32_16x16x32_bf16 v[64:67], v[208:211], v[192:195], v[64:67]
    v_mfma_f32_16x16x32_bf16 v[68:71], v[212:215], v[192:195], v[68:71]
    v_mfma_f32_16x16x32_bf16 v[72:75], v[216:219], v[192:195], v[72:75]
    v_mfma_f32_16x16x32_bf16 v[76:79], v[220:223], v[192:195], v[76:79]
    v_mfma_f32_16x16x32_bf16 v[80:83], v[208:211], v[196:199], v[80:83]
    v_mfma_f32_16x16x32_bf16 v[84:87], v[212:215], v[196:199], v[84:87]
    v_mfma_f32_16x16x32_bf16 v[88:91], v[216:219], v[196:199], v[88:91]
    v_mfma_f32_16x16x32_bf16 v[92:95], v[220:223], v[196:199], v[92:95]
    v_mfma_f32_16x16x32_bf16 v[96:99], v[208:211], v[200:203], v[96:99]
    v_mfma_f32_16x16x32_bf16 v[100:103], v[212:215], v[200:203], v[100:103]
    v_mfma_f32_16x16x32_bf16 v[104:107], v[216:219], v[200:203], v[104:107]
    v_mfma_f32_16x16x32_bf16 v[108:111], v[220:223], v[200:203], v[108:111]
    v_mfma_f32_16x16x32_bf16 v[112:115], v[208:211], v[204:207], v[112:115]
    v_mfma_f32_16x16x32_bf16 v[116:119], v[212:215], v[204:207], v[116:119]
    v_mfma_f32_16x16x32_bf16 v[120:123], v[216:219], v[204:207], v[120:123]
    v_mfma_f32_16x16x32_bf16 v[124:127], v[220:223], v[204:207], v[124:127]
    s_waitcnt lgkmcnt(9)
    v_mfma_f32_16x16x32_bf16 v[0:3], v[160:163], v[128:131], v[0:3]
    ds_read_b128 v[176:179], v225 offset:0
    s_waitcnt lgkmcnt(8)
    v_mfma_f32_16x16x32_bf16 v[4:7], v[164:167], v[128:131], v[4:7]
    ds_read_b64_tr_b16 v[208:209], v226 offset:8192
    s_waitcnt lgkmcnt(7)
    v_mfma_f32_16x16x32_bf16 v[8:11], v[168:171], v[128:131], v[8:11]
    ds_read_b64_tr_b16 v[210:211], v226 offset:9216
    s_waitcnt lgkmcnt(6)
    v_mfma_f32_16x16x32_bf16 v[12:15], v[172:175], v[128:131], v[12:15]
    ds_read_b64_tr_b16 v[212:213], v226 offset:24576
    s_waitcnt lgkmcnt(6)
    v_mfma_f32_16x16x32_bf16 v[16:19], v[160:163], v[132:135], v[16:19]
    ds_read_b64_tr_b16 v[214:215], v226 offset:25600
    v_mfma_f32_16x16x32_bf16 v[20:23], v[164:167], v[132:135], v[20:23]
    ds_read_b64_tr_b16 v[216:217], v227 offset:8192
    v_mfma_f32_16x16x32_bf16 v[24:27], v[168:171], v[132:135], v[24:27]
    ds_read_b64_tr_b16 v[218:219], v227 offset:9216
    v_mfma_f32_16x16x32_bf16 v[28:31], v[172:175], v[132:135], v[28:31]
    ds_read_b64_tr_b16 v[220:221], v227 offset:24576
    s_waitcnt lgkmcnt(9)
    v_mfma_f32_16x16x32_bf16 v[32:35], v[160:163], v[136:139], v[32:35]
    ds_read_b64_tr_b16 v[222:223], v227 offset:25600
    v_mfma_f32_16x16x32_bf16 v[36:39], v[164:167], v[136:139], v[36:39]
    ds_read_b128 v[180:183], v225 offset:2048
    v_mfma_f32_16x16x32_bf16 v[40:43], v[168:171], v[136:139], v[40:43]
    ds_read_b128 v[184:187], v225 offset:4096
    v_mfma_f32_16x16x32_bf16 v[44:47], v[172:175], v[136:139], v[44:47]
    ds_read_b128 v[188:191], v225 offset:6144
    s_waitcnt lgkmcnt(12)
    v_mfma_f32_16x16x32_bf16 v[48:51], v[160:163], v[140:143], v[48:51]
    v_mfma_f32_16x16x32_bf16 v[52:55], v[164:167], v[140:143], v[52:55]
    v_mfma_f32_16x16x32_bf16 v[56:59], v[168:171], v[140:143], v[56:59]
    v_mfma_f32_16x16x32_bf16 v[60:63], v[172:175], v[140:143], v[60:63]
    s_waitcnt lgkmcnt(9)
    v_mfma_f32_16x16x32_bf16 v[0:3], v[208:211], v[176:179], v[0:3]
    v_add_u32 v224, 4294918144, v224
    v_add_u32 v225, 4294918144, v225
    s_waitcnt lgkmcnt(7)
    v_mfma_f32_16x16x32_bf16 v[4:7], v[212:215], v[176:179], v[4:7]
    v_add_u32 v226, 4294918144, v226
    v_add_u32 v227, 4294918144, v227
    s_barrier
    s_waitcnt lgkmcnt(5)
    v_mfma_f32_16x16x32_bf16 v[8:11], v[216:219], v[176:179], v[8:11]
    ds_read_b128 v[128:131], v224 offset:0
    s_waitcnt lgkmcnt(4)
    v_mfma_f32_16x16x32_bf16 v[12:15], v[220:223], v[176:179], v[12:15]
    ds_read_b64_tr_b16 v[160:161], v226 offset:0
    s_waitcnt lgkmcnt(4)
    v_mfma_f32_16x16x32_bf16 v[16:19], v[208:211], v[180:183], v[16:19]
    ds_read_b64_tr_b16 v[162:163], v226 offset:1024
    v_mfma_f32_16x16x32_bf16 v[20:23], v[212:215], v[180:183], v[20:23]
    ds_read_b64_tr_b16 v[164:165], v226 offset:16384
    v_mfma_f32_16x16x32_bf16 v[24:27], v[216:219], v[180:183], v[24:27]
    ds_read_b64_tr_b16 v[166:167], v226 offset:17408
    v_mfma_f32_16x16x32_bf16 v[28:31], v[220:223], v[180:183], v[28:31]
    ds_read_b64_tr_b16 v[168:169], v227 offset:0
    s_waitcnt lgkmcnt(7)
    v_mfma_f32_16x16x32_bf16 v[32:35], v[208:211], v[184:187], v[32:35]
    ds_read_b64_tr_b16 v[170:171], v227 offset:1024
    v_mfma_f32_16x16x32_bf16 v[36:39], v[212:215], v[184:187], v[36:39]
    ds_read_b64_tr_b16 v[172:173], v227 offset:16384
    v_mfma_f32_16x16x32_bf16 v[40:43], v[216:219], v[184:187], v[40:43]
    ds_read_b64_tr_b16 v[174:175], v227 offset:17408
    v_mfma_f32_16x16x32_bf16 v[44:47], v[220:223], v[184:187], v[44:47]
    ds_read_b128 v[132:135], v224 offset:2048
    s_waitcnt lgkmcnt(10)
    v_mfma_f32_16x16x32_bf16 v[48:51], v[208:211], v[188:191], v[48:51]
    ds_read_b128 v[136:139], v224 offset:4096
    v_mfma_f32_16x16x32_bf16 v[52:55], v[212:215], v[188:191], v[52:55]
    ds_read_b128 v[140:143], v224 offset:6144
    v_mfma_f32_16x16x32_bf16 v[56:59], v[216:219], v[188:191], v[56:59]
    v_mfma_f32_16x16x32_bf16 v[60:63], v[220:223], v[188:191], v[60:63]
    s_waitcnt lgkmcnt(9)
    v_mfma_f32_16x16x32_bf16 v[0:3], v[160:163], v[128:131], v[0:3]
    ds_read_b128 v[176:179], v225 offset:0
    s_waitcnt lgkmcnt(8)
    v_mfma_f32_16x16x32_bf16 v[4:7], v[164:167], v[128:131], v[4:7]
    ds_read_b64_tr_b16 v[208:209], v226 offset:8192
    s_waitcnt lgkmcnt(7)
    v_mfma_f32_16x16x32_bf16 v[8:11], v[168:171], v[128:131], v[8:11]
    ds_read_b64_tr_b16 v[210:211], v226 offset:9216
    s_waitcnt lgkmcnt(6)
    v_mfma_f32_16x16x32_bf16 v[12:15], v[172:175], v[128:131], v[12:15]
    ds_read_b64_tr_b16 v[212:213], v226 offset:24576
    s_waitcnt lgkmcnt(6)
    v_mfma_f32_16x16x32_bf16 v[16:19], v[160:163], v[132:135], v[16:19]
    ds_read_b64_tr_b16 v[214:215], v226 offset:25600
    v_mfma_f32_16x16x32_bf16 v[20:23], v[164:167], v[132:135], v[20:23]
    ds_read_b64_tr_b16 v[216:217], v227 offset:8192
    v_mfma_f32_16x16x32_bf16 v[24:27], v[168:171], v[132:135], v[24:27]
    ds_read_b64_tr_b16 v[218:219], v227 offset:9216
    v_mfma_f32_16x16x32_bf16 v[28:31], v[172:175], v[132:135], v[28:31]
    ds_read_b64_tr_b16 v[220:221], v227 offset:24576
    s_waitcnt lgkmcnt(9)
    v_mfma_f32_16x16x32_bf16 v[32:35], v[160:163], v[136:139], v[32:35]
    ds_read_b64_tr_b16 v[222:223], v227 offset:25600
    v_mfma_f32_16x16x32_bf16 v[36:39], v[164:167], v[136:139], v[36:39]
    ds_read_b128 v[180:183], v225 offset:2048
    v_mfma_f32_16x16x32_bf16 v[40:43], v[168:171], v[136:139], v[40:43]
    ds_read_b128 v[184:187], v225 offset:4096
    v_mfma_f32_16x16x32_bf16 v[44:47], v[172:175], v[136:139], v[44:47]
    ds_read_b128 v[188:191], v225 offset:6144
    s_waitcnt lgkmcnt(12)
    v_mfma_f32_16x16x32_bf16 v[48:51], v[160:163], v[140:143], v[48:51]
    v_mfma_f32_16x16x32_bf16 v[52:55], v[164:167], v[140:143], v[52:55]
    v_mfma_f32_16x16x32_bf16 v[56:59], v[168:171], v[140:143], v[56:59]
    v_mfma_f32_16x16x32_bf16 v[60:63], v[172:175], v[140:143], v[60:63]
    s_waitcnt lgkmcnt(9)
    v_mfma_f32_16x16x32_bf16 v[0:3], v[208:211], v[176:179], v[0:3]
    v_add_u32 v224, 49152, v224
    v_add_u32 v225, 49152, v225
    s_waitcnt lgkmcnt(7)
    v_mfma_f32_16x16x32_bf16 v[4:7], v[212:215], v[176:179], v[4:7]
    v_add_u32 v226, 49152, v226
    v_add_u32 v227, 49152, v227
    s_waitcnt lgkmcnt(5)
    v_mfma_f32_16x16x32_bf16 v[8:11], v[216:219], v[176:179], v[8:11]
    ds_read_b128 v[144:147], v224 offset:8192
    s_waitcnt lgkmcnt(4)
    v_mfma_f32_16x16x32_bf16 v[12:15], v[220:223], v[176:179], v[12:15]
    ds_read_b64_tr_b16 v[160:161], v226 offset:0
    s_waitcnt lgkmcnt(4)
    v_mfma_f32_16x16x32_bf16 v[16:19], v[208:211], v[180:183], v[16:19]
    ds_read_b64_tr_b16 v[162:163], v226 offset:1024
    v_mfma_f32_16x16x32_bf16 v[20:23], v[212:215], v[180:183], v[20:23]
    ds_read_b64_tr_b16 v[164:165], v226 offset:16384
    v_mfma_f32_16x16x32_bf16 v[24:27], v[216:219], v[180:183], v[24:27]
    ds_read_b64_tr_b16 v[166:167], v226 offset:17408
    v_mfma_f32_16x16x32_bf16 v[28:31], v[220:223], v[180:183], v[28:31]
    ds_read_b64_tr_b16 v[168:169], v227 offset:0
    s_waitcnt lgkmcnt(7)
    v_mfma_f32_16x16x32_bf16 v[32:35], v[208:211], v[184:187], v[32:35]
    ds_read_b64_tr_b16 v[170:171], v227 offset:1024
    v_mfma_f32_16x16x32_bf16 v[36:39], v[212:215], v[184:187], v[36:39]
    ds_read_b64_tr_b16 v[172:173], v227 offset:16384
    v_mfma_f32_16x16x32_bf16 v[40:43], v[216:219], v[184:187], v[40:43]
    ds_read_b64_tr_b16 v[174:175], v227 offset:17408
    v_mfma_f32_16x16x32_bf16 v[44:47], v[220:223], v[184:187], v[44:47]
    ds_read_b128 v[148:151], v224 offset:10240
    s_waitcnt lgkmcnt(10)
    v_mfma_f32_16x16x32_bf16 v[48:51], v[208:211], v[188:191], v[48:51]
    ds_read_b128 v[152:155], v224 offset:12288
    v_mfma_f32_16x16x32_bf16 v[52:55], v[212:215], v[188:191], v[52:55]
    ds_read_b128 v[156:159], v224 offset:14336
    v_mfma_f32_16x16x32_bf16 v[56:59], v[216:219], v[188:191], v[56:59]
    v_mfma_f32_16x16x32_bf16 v[60:63], v[220:223], v[188:191], v[60:63]
    s_waitcnt lgkmcnt(9)
    v_mfma_f32_16x16x32_bf16 v[64:67], v[160:163], v[144:147], v[64:67]
    ds_read_b128 v[192:195], v225 offset:8192
    v_mul_f32 v0, v0, v4
    s_waitcnt lgkmcnt(8)
    v_mfma_f32_16x16x32_bf16 v[68:71], v[164:167], v[144:147], v[68:71]
    ds_read_b64_tr_b16 v[208:209], v226 offset:8192
    v_mul_f32 v1, v1, v5
    s_waitcnt lgkmcnt(7)
    v_mfma_f32_16x16x32_bf16 v[72:75], v[168:171], v[144:147], v[72:75]
    ds_read_b64_tr_b16 v[210:211], v226 offset:9216
    v_mul_f32 v2, v2, v6
    s_waitcnt lgkmcnt(6)
    v_mfma_f32_16x16x32_bf16 v[76:79], v[172:175], v[144:147], v[76:79]
    ds_read_b64_tr_b16 v[212:213], v226 offset:24576
    v_mul_f32 v3, v3, v7
    s_waitcnt lgkmcnt(6)
    v_mfma_f32_16x16x32_bf16 v[80:83], v[160:163], v[148:151], v[80:83]
    ds_read_b64_tr_b16 v[214:215], v226 offset:25600
    v_mul_f32 v8, v8, v12
    v_mfma_f32_16x16x32_bf16 v[84:87], v[164:167], v[148:151], v[84:87]
    ds_read_b64_tr_b16 v[216:217], v227 offset:8192
    v_mul_f32 v9, v9, v13
    v_mfma_f32_16x16x32_bf16 v[88:91], v[168:171], v[148:151], v[88:91]
    ds_read_b64_tr_b16 v[218:219], v227 offset:9216
    v_mul_f32 v10, v10, v14
    v_mfma_f32_16x16x32_bf16 v[92:95], v[172:175], v[148:151], v[92:95]
    ds_read_b64_tr_b16 v[220:221], v227 offset:24576
    v_mul_f32 v11, v11, v15
    s_waitcnt lgkmcnt(9)
    v_mfma_f32_16x16x32_bf16 v[96:99], v[160:163], v[152:155], v[96:99]
    ds_read_b64_tr_b16 v[222:223], v227 offset:25600
    v_cvt_pk_bf16_f32 v4, v0, v1
    v_mfma_f32_16x16x32_bf16 v[100:103], v[164:167], v[152:155], v[100:103]
    ds_read_b128 v[196:199], v225 offset:10240
    v_cvt_pk_bf16_f32 v5, v2, v3
    v_mfma_f32_16x16x32_bf16 v[104:107], v[168:171], v[152:155], v[104:107]
    ds_read_b128 v[200:203], v225 offset:12288
    v_cvt_pk_bf16_f32 v6, v8, v9
    v_mfma_f32_16x16x32_bf16 v[108:111], v[172:175], v[152:155], v[108:111]
    ds_read_b128 v[204:207], v225 offset:14336
    v_cvt_pk_bf16_f32 v7, v10, v11
    s_waitcnt lgkmcnt(12)
    v_mfma_f32_16x16x32_bf16 v[112:115], v[160:163], v[156:159], v[112:115]
    buffer_store_dwordx4 v[4:7], v231, s[44:47], s8 offen offset:0 sc1
    v_mul_f32 v16, v16, v20
    v_mfma_f32_16x16x32_bf16 v[116:119], v[164:167], v[156:159], v[116:119]
    v_mul_f32 v17, v17, v21
    v_mul_f32 v18, v18, v22
    v_mfma_f32_16x16x32_bf16 v[120:123], v[168:171], v[156:159], v[120:123]
    v_mul_f32 v19, v19, v23
    v_mul_f32 v24, v24, v28
    v_mfma_f32_16x16x32_bf16 v[124:127], v[172:175], v[156:159], v[124:127]
    v_mul_f32 v25, v25, v29
    v_mul_f32 v26, v26, v30
    s_waitcnt lgkmcnt(0)
    v_mfma_f32_16x16x32_bf16 v[64:67], v[208:211], v[192:195], v[64:67]
    s_mov_b64 exec, 1
    ds_add_u32 v233, v234 offset:44
    s_mov_b64 exec, -1
    v_add_u32 v224, 4294918144, v224
    v_add_u32 v225, 4294918144, v225
    v_mfma_f32_16x16x32_bf16 v[68:71], v[212:215], v[192:195], v[68:71]
    v_add_u32 v226, 4294918144, v226
    v_add_u32 v227, 4294918144, v227
    v_mfma_f32_16x16x32_bf16 v[72:75], v[216:219], v[192:195], v[72:75]
    ds_read_b128 v[144:147], v224 offset:8192
    v_mul_f32 v27, v27, v31
    v_mfma_f32_16x16x32_bf16 v[76:79], v[220:223], v[192:195], v[76:79]
    ds_read_b64_tr_b16 v[160:161], v226 offset:0
    v_cvt_pk_bf16_f32 v20, v16, v17
    v_mfma_f32_16x16x32_bf16 v[80:83], v[208:211], v[196:199], v[80:83]
    ds_read_b64_tr_b16 v[162:163], v226 offset:1024
    v_cvt_pk_bf16_f32 v21, v18, v19
    v_mfma_f32_16x16x32_bf16 v[84:87], v[212:215], v[196:199], v[84:87]
    ds_read_b64_tr_b16 v[164:165], v226 offset:16384
    v_cvt_pk_bf16_f32 v22, v24, v25
    v_mfma_f32_16x16x32_bf16 v[88:91], v[216:219], v[196:199], v[88:91]
    ds_read_b64_tr_b16 v[166:167], v226 offset:17408
    v_cvt_pk_bf16_f32 v23, v26, v27
    v_mfma_f32_16x16x32_bf16 v[92:95], v[220:223], v[196:199], v[92:95]
    ds_read_b64_tr_b16 v[168:169], v227 offset:0
    buffer_store_dwordx4 v[20:23], v231, s[44:47], s8 offen offset:256 sc1
    v_mfma_f32_16x16x32_bf16 v[96:99], v[208:211], v[200:203], v[96:99]
    ds_read_b64_tr_b16 v[170:171], v227 offset:1024
    v_mul_f32 v32, v32, v36
    v_mfma_f32_16x16x32_bf16 v[100:103], v[212:215], v[200:203], v[100:103]
    ds_read_b64_tr_b16 v[172:173], v227 offset:16384
    v_mul_f32 v33, v33, v37
    v_mfma_f32_16x16x32_bf16 v[104:107], v[216:219], v[200:203], v[104:107]
    ds_read_b64_tr_b16 v[174:175], v227 offset:17408
    v_mul_f32 v34, v34, v38
    v_mfma_f32_16x16x32_bf16 v[108:111], v[220:223], v[200:203], v[108:111]
    ds_read_b128 v[148:151], v224 offset:10240
    v_mul_f32 v35, v35, v39
    v_mfma_f32_16x16x32_bf16 v[112:115], v[208:211], v[204:207], v[112:115]
    ds_read_b128 v[152:155], v224 offset:12288
    v_mul_f32 v40, v40, v44
    v_mfma_f32_16x16x32_bf16 v[116:119], v[212:215], v[204:207], v[116:119]
    ds_read_b128 v[156:159], v224 offset:14336
    v_mul_f32 v41, v41, v45
    v_mfma_f32_16x16x32_bf16 v[120:123], v[216:219], v[204:207], v[120:123]
    v_mul_f32 v42, v42, v46
    v_mul_f32 v43, v43, v47
    v_mfma_f32_16x16x32_bf16 v[124:127], v[220:223], v[204:207], v[124:127]
    v_cvt_pk_bf16_f32 v36, v32, v33
    v_cvt_pk_bf16_f32 v37, v34, v35
    s_waitcnt lgkmcnt(9)
    v_mfma_f32_16x16x32_bf16 v[64:67], v[160:163], v[144:147], v[64:67]
    ds_read_b128 v[192:195], v225 offset:8192
    v_cvt_pk_bf16_f32 v38, v40, v41
    s_waitcnt lgkmcnt(8)
    v_mfma_f32_16x16x32_bf16 v[68:71], v[164:167], v[144:147], v[68:71]
    ds_read_b64_tr_b16 v[208:209], v226 offset:8192
    v_cvt_pk_bf16_f32 v39, v42, v43
    s_waitcnt lgkmcnt(7)
    v_mfma_f32_16x16x32_bf16 v[72:75], v[168:171], v[144:147], v[72:75]
    ds_read_b64_tr_b16 v[210:211], v226 offset:9216
    buffer_store_dwordx4 v[36:39], v231, s[44:47], s9 offen offset:0 sc1
    s_waitcnt lgkmcnt(6)
    v_mfma_f32_16x16x32_bf16 v[76:79], v[172:175], v[144:147], v[76:79]
    ds_read_b64_tr_b16 v[212:213], v226 offset:24576
    v_mul_f32 v48, v48, v52
    s_waitcnt lgkmcnt(6)
    v_mfma_f32_16x16x32_bf16 v[80:83], v[160:163], v[148:151], v[80:83]
    ds_read_b64_tr_b16 v[214:215], v226 offset:25600
    v_mul_f32 v49, v49, v53
    v_mfma_f32_16x16x32_bf16 v[84:87], v[164:167], v[148:151], v[84:87]
    ds_read_b64_tr_b16 v[216:217], v227 offset:8192
    v_mul_f32 v50, v50, v54
    v_mfma_f32_16x16x32_bf16 v[88:91], v[168:171], v[148:151], v[88:91]
    ds_read_b64_tr_b16 v[218:219], v227 offset:9216
    v_mul_f32 v51, v51, v55
    v_mfma_f32_16x16x32_bf16 v[92:95], v[172:175], v[148:151], v[92:95]
    ds_read_b64_tr_b16 v[220:221], v227 offset:24576
    v_mul_f32 v56, v56, v60
    s_waitcnt lgkmcnt(9)
    v_mfma_f32_16x16x32_bf16 v[96:99], v[160:163], v[152:155], v[96:99]
    ds_read_b64_tr_b16 v[222:223], v227 offset:25600
    v_mul_f32 v57, v57, v61
    v_mfma_f32_16x16x32_bf16 v[100:103], v[164:167], v[152:155], v[100:103]
    ds_read_b128 v[196:199], v225 offset:10240
    v_mul_f32 v58, v58, v62
    v_mfma_f32_16x16x32_bf16 v[104:107], v[168:171], v[152:155], v[104:107]
    ds_read_b128 v[200:203], v225 offset:12288
    v_mul_f32 v59, v59, v63
    v_mfma_f32_16x16x32_bf16 v[108:111], v[172:175], v[152:155], v[108:111]
    ds_read_b128 v[204:207], v225 offset:14336
    v_cvt_pk_bf16_f32 v52, v48, v49
    s_waitcnt lgkmcnt(12)
    v_mfma_f32_16x16x32_bf16 v[112:115], v[160:163], v[156:159], v[112:115]
    v_cvt_pk_bf16_f32 v53, v50, v51
    v_cvt_pk_bf16_f32 v54, v56, v57
    v_mfma_f32_16x16x32_bf16 v[116:119], v[164:167], v[156:159], v[116:119]
    v_cvt_pk_bf16_f32 v55, v58, v59
    buffer_store_dwordx4 v[52:55], v231, s[44:47], s9 offen offset:256 sc1
    v_mfma_f32_16x16x32_bf16 v[120:123], v[168:171], v[156:159], v[120:123]
    v_mfma_f32_16x16x32_bf16 v[124:127], v[172:175], v[156:159], v[124:127]
    s_waitcnt lgkmcnt(0)
    v_mfma_f32_16x16x32_bf16 v[64:67], v[208:211], v[192:195], v[64:67]
    s_mov_b64 exec, 1
    ds_add_u32 v233, v234 offset:56
    s_mov_b64 exec, -1
    v_mfma_f32_16x16x32_bf16 v[68:71], v[212:215], v[192:195], v[68:71]
    v_mfma_f32_16x16x32_bf16 v[72:75], v[216:219], v[192:195], v[72:75]
    v_mfma_f32_16x16x32_bf16 v[76:79], v[220:223], v[192:195], v[76:79]
    v_mfma_f32_16x16x32_bf16 v[80:83], v[208:211], v[196:199], v[80:83]
    v_mfma_f32_16x16x32_bf16 v[84:87], v[212:215], v[196:199], v[84:87]
    v_mfma_f32_16x16x32_bf16 v[88:91], v[216:219], v[196:199], v[88:91]
    v_mfma_f32_16x16x32_bf16 v[92:95], v[220:223], v[196:199], v[92:95]
    v_mfma_f32_16x16x32_bf16 v[96:99], v[208:211], v[200:203], v[96:99]
    v_mfma_f32_16x16x32_bf16 v[100:103], v[212:215], v[200:203], v[100:103]
    v_mfma_f32_16x16x32_bf16 v[104:107], v[216:219], v[200:203], v[104:107]
    v_mfma_f32_16x16x32_bf16 v[108:111], v[220:223], v[200:203], v[108:111]
    v_mfma_f32_16x16x32_bf16 v[112:115], v[208:211], v[204:207], v[112:115]
    v_mfma_f32_16x16x32_bf16 v[116:119], v[212:215], v[204:207], v[116:119]
    v_mfma_f32_16x16x32_bf16 v[120:123], v[216:219], v[204:207], v[120:123]
    v_mfma_f32_16x16x32_bf16 v[124:127], v[220:223], v[204:207], v[124:127]
    s_waitcnt lgkmcnt(0)
    s_cmp_lg_u32 s56, 0
    s_cbranch_scc1 L_TAGD39
    s_mov_b32 s49, 0
    v_mov_b32 v130, 0
L_TAG38:
    s_sleep 8
    global_load_dwordx2 v[128:129], v130, s[62:63] sc1
    s_waitcnt vmcnt(0)
    v_readfirstlane_b32 s56, v128
    v_readfirstlane_b32 s57, v129
    s_add_u32 s49, s49, 1
    s_cmp_lt_u32 s49, 200000
    s_cselect_b32 s48, s56, 1
    s_cmp_eq_u32 s48, 0
    s_cbranch_scc1 L_TAG38
    s_nop 4
L_TAGD39:
    s_waitcnt vmcnt(0)
    s_mov_b64 exec, 1
    ds_add_rtn_u32 v128, v233, v234 offset:0
    s_mov_b64 exec, -1
    s_waitcnt lgkmcnt(0)
    v_readfirstlane_b32 s48, v128
    s_nop 0
    s_cmp_lg_u32 s48, 3
    s_cbranch_scc1 L_NOF40
    s_lshl_b32 s48, s59, 7
    s_add_u32 s48, s48, 12681216
    v_mov_b32 v130, s48
    v_mov_b32 v128, s56
    v_mov_b32 v129, s57
    s_mov_b64 exec, 1
    global_store_dwordx2 v130, v[128:129], s[18:19] sc1
    s_mov_b64 exec, -1
L_NOF40:
    s_nop 4
    v_mul_f32 v64, v64, v68
    v_mul_f32 v65, v65, v69
    v_mul_f32 v66, v66, v70
    v_mul_f32 v67, v67, v71
    v_mul_f32 v72, v72, v76
    v_mul_f32 v73, v73, v77
    v_mul_f32 v74, v74, v78
    v_mul_f32 v75, v75, v79
    v_cvt_pk_bf16_f32 v68, v64, v65
    v_cvt_pk_bf16_f32 v69, v66, v67
    v_cvt_pk_bf16_f32 v70, v72, v73
    v_cvt_pk_bf16_f32 v71, v74, v75
    buffer_store_dwordx4 v[68:71], v231, s[44:47], s10 offen offset:0 sc1
    v_mul_f32 v80, v80, v84
    v_mul_f32 v81, v81, v85
    v_mul_f32 v82, v82, v86
    v_mul_f32 v83, v83, v87
    v_mul_f32 v88, v88, v92
    v_mul_f32 v89, v89, v93
    v_mul_f32 v90, v90, v94
    v_mul_f32 v91, v91, v95
    v_cvt_pk_bf16_f32 v84, v80, v81
    v_cvt_pk_bf16_f32 v85, v82, v83
    v_cvt_pk_bf16_f32 v86, v88, v89
    v_cvt_pk_bf16_f32 v87, v90, v91
    buffer_store_dwordx4 v[84:87], v231, s[44:47], s10 offen offset:256 sc1
    v_mul_f32 v96, v96, v100
    v_mul_f32 v97, v97, v101
    v_mul_f32 v98, v98, v102
    v_mul_f32 v99, v99, v103
    v_mul_f32 v104, v104, v108
    v_mul_f32 v105, v105, v109
    v_mul_f32 v106, v106, v110
    v_mul_f32 v107, v107, v111
    v_cvt_pk_bf16_f32 v100, v96, v97
    v_cvt_pk_bf16_f32 v101, v98, v99
    v_cvt_pk_bf16_f32 v102, v104, v105
    v_cvt_pk_bf16_f32 v103, v106, v107
    buffer_store_dwordx4 v[100:103], v231, s[44:47], s11 offen offset:0 sc1
    v_mul_f32 v112, v112, v116
    v_mul_f32 v113, v113, v117
    v_mul_f32 v114, v114, v118
    v_mul_f32 v115, v115, v119
    v_mul_f32 v120, v120, v124
    v_mul_f32 v121, v121, v125
    v_mul_f32 v122, v122, v126
    v_mul_f32 v123, v123, v127
    v_cvt_pk_bf16_f32 v116, v112, v113
    v_cvt_pk_bf16_f32 v117, v114, v115
    v_cvt_pk_bf16_f32 v118, v120, v121
    v_cvt_pk_bf16_f32 v119, v122, v123
    buffer_store_dwordx4 v[116:119], v231, s[44:47], s11 offen offset:256 sc1
    s_mov_b32 s49, 0
L_SPIN41:
    ds_read_b32 v132, v233 offset:56
    s_waitcnt lgkmcnt(0)
    v_readfirstlane_b32 s48, v132
    s_nop 0
    s_cmp_ge_u32 s48, 4
    s_cbranch_scc1 L_SPUN42
    s_sleep 1
    s_add_u32 s49, s49, 1
    s_cmp_lt_u32 s49, 3200000
    s_cbranch_scc1 L_SPIN41
L_SPUN42:
L_S1:
    global_load_dwordx2 v[208:209], v243, s[18:19] sc1
    s_waitcnt vmcnt(0)
    s_mov_b64 exec, 1
    ds_add_rtn_u32 v132, v233, v234 offset:4
    s_mov_b64 exec, -1
    s_waitcnt lgkmcnt(0)
    v_readfirstlane_b32 s48, v132
    s_nop 0
    s_cmp_lg_u32 s48, 3
    s_cbranch_scc1 L_NOF43
    s_lshl_b32 s48, s59, 7
    s_add_u32 s48, s48, 12746752
    v_mov_b32 v134, s48
    v_mov_b32 v132, s56
    v_mov_b32 v133, s57
    s_mov_b64 exec, 1
    global_store_dwordx2 v134, v[132:133], s[18:19] sc1
    s_mov_b64 exec, -1
L_NOF43:
    s_mov_b32 s49, 0
    s_branch L_POLC45
L_POLL44:
    global_load_dwordx2 v[208:209], v243, s[18:19] sc1
    s_waitcnt vmcnt(0)
L_POLC45:
    v_cmp_ne_u64 vcc, s[56:57], v[208:209]
    s_nop 0
    s_cmp_eq_u64 vcc, 0
    s_cbranch_scc1 L_POLD46
    s_sleep 2
    s_add_u32 s49, s49, 1
    s_cmp_lt_u32 s49, 200000
    s_cbranch_scc1 L_POLL44
L_POLD46:
    buffer_load_dwordx4 v[80:83], v230, s[44:47], s42 offen offset:0 sc1
    buffer_load_dwordx4 v[84:87], v230, s[44:47], s42 offen offset:1024 sc1
    buffer_load_dwordx4 v[88:91], v230, s[44:47], s42 offen offset:2048 sc1
    buffer_load_dwordx4 v[92:95], v230, s[44:47], s42 offen offset:3072 sc1
    s_add_u32 s42, s42, 4096
    buffer_load_dwordx4 v[96:99], v230, s[44:47], s42 offen offset:0 sc1
    buffer_load_dwordx4 v[100:103], v230, s[44:47], s42 offen offset:1024 sc1
    buffer_load_dwordx4 v[104:107], v230, s[44:47], s42 offen offset:2048 sc1
    buffer_load_dwordx4 v[108:111], v230, s[44:47], s42 offen offset:3072 sc1
    s_lshr_b32 s48, s23, 1
    s_lshl_b32 s48, s48, 15
    s_and_b32 s49, s23, 1
    s_lshl_b32 s49, s49, 13
    s_add_u32 s48, s48, s49
    s_add_u32 s49, s48, 262144
    s_lshl_b32 s48, s23, 12
    s_add_u32 m0, s48, 0
    s_nop 0
    buffer_load_dwordx4 v235, s[36:39], s49 offen offset:0 lds
    buffer_load_dwordx4 v236, s[36:39], s49 offen offset:1024 lds
    buffer_load_dwordx4 v237, s[36:39], s49 offen offset:2048 lds
    buffer_load_dwordx4 v238, s[36:39], s49 offen offset:3072 lds
    s_lshr_b32 s48, s23, 1
    s_lshl_b32 s48, s48, 15
    s_and_b32 s49, s23, 1
    s_lshl_b32 s49, s49, 13
    s_add_u32 s48, s48, s49
    s_add_u32 s49, s48, 327680
    s_lshl_b32 s48, s23, 12
    s_add_u32 m0, s48, 16384
    s_nop 0
    buffer_load_dwordx4 v235, s[36:39], s49 offen offset:0 lds
    buffer_load_dwordx4 v236, s[36:39], s49 offen offset:1024 lds
    buffer_load_dwordx4 v237, s[36:39], s49 offen offset:2048 lds
    buffer_load_dwordx4 v238, s[36:39], s49 offen offset:3072 lds
    s_lshr_b32 s48, s23, 1
    s_lshl_b32 s48, s48, 15
    s_and_b32 s49, s23, 1
    s_lshl_b32 s49, s49, 13
    s_add_u32 s48, s48, s49
    s_add_u32 s49, s48, 393216
    s_lshl_b32 s48, s23, 12
    s_add_u32 m0, s48, 32768
    s_nop 0
    buffer_load_dwordx4 v235, s[36:39], s49 offen offset:0 lds
    buffer_load_dwordx4 v236, s[36:39], s49 offen offset:1024 lds
    buffer_load_dwordx4 v237, s[36:39], s49 offen offset:2048 lds
    buffer_load_dwordx4 v238, s[36:39], s49 offen offset:3072 lds
    s_mov_b32 s49, 0
L_SPIN47:
    ds_read_b32 v210, v233 offset:8
    s_waitcnt lgkmcnt(0)
    v_readfirstlane_b32 s48, v210
    s_nop 0
    s_cmp_ge_u32 s48, 4
    s_cbranch_scc1 L_SPUN48
    s_sleep 1
    s_add_u32 s49, s49, 1
    s_cmp_lt_u32 s49, 3200000
    s_cbranch_scc1 L_SPIN47
L_SPUN48:
    ds_read_b64_tr_b16 v[64:65], v241 offset:32768
    ds_read_b64_tr_b16 v[66:67], v241 offset:33792
    ds_read_b64_tr_b16 v[68:69], v242 offset:32768
    ds_read_b64_tr_b16 v[70:71], v242 offset:33792
    ds_read_b64_tr_b16 v[72:73], v241 offset:36864
    ds_read_b64_tr_b16 v[74:75], v241 offset:37888
    ds_read_b64_tr_b16 v[76:77], v242 offset:36864
    ds_read_b64_tr_b16 v[78:79], v242 offset:37888
    s_waitcnt vmcnt(19)
    s_waitcnt lgkmcnt(4)
    v_mfma_f32_32x32x16_bf16 v[0:15], v[64:67], v[80:83], 0
    v_mfma_f32_32x32x16_bf16 v[16:31], v[68:71], v[80:83], 0
    s_add_u32 s42, s42, 4096
    buffer_load_dwordx4 v[112:115], v230, s[44:47], s42 offen offset:0 sc1
    ds_read_b64_tr_b16 v[64:65], v241 offset:40960
    ds_read_b64_tr_b16 v[66:67], v241 offset:41984
    ds_read_b64_tr_b16 v[68:69], v242 offset:40960
    ds_read_b64_tr_b16 v[70:71], v242 offset:41984
    s_waitcnt vmcnt(19)
    s_waitcnt lgkmcnt(4)
    v_mfma_f32_32x32x16_bf16 v[0:15], v[72:75], v[84:87], v[0:15]
    v_mfma_f32_32x32x16_bf16 v[16:31], v[76:79], v[84:87], v[16:31]
    buffer_load_dwordx4 v[116:119], v230, s[44:47], s42 offen offset:1024 sc1
    ds_read_b64_tr_b16 v[72:73], v241 offset:45056
    ds_read_b64_tr_b16 v[74:75], v241 offset:46080
    ds_read_b64_tr_b16 v[76:77], v242 offset:45056
    ds_read_b64_tr_b16 v[78:79], v242 offset:46080
    s_waitcnt vmcnt(19)
    s_waitcnt lgkmcnt(4)
    v_mfma_f32_32x32x16_bf16 v[0:15], v[64:67], v[88:91], v[0:15]
    v_mfma_f32_32x32x16_bf16 v[16:31], v[68:71], v[88:91], v[16:31]
    buffer_load_dwordx4 v[120:123], v230, s[44:47], s42 offen offset:2048 sc1
    ds_read_b64_tr_b16 v[64:65], v239 offset:49152
    ds_read_b64_tr_b16 v[66:67], v239 offset:50176
    ds_read_b64_tr_b16 v[68:69], v240 offset:49152
    ds_read_b64_tr_b16 v[70:71], v240 offset:50176
    s_waitcnt vmcnt(19)
    s_waitcnt lgkmcnt(4)
    v_mfma_f32_32x32x16_bf16 v[0:15], v[72:75], v[92:95], v[0:15]
    v_mfma_f32_32x32x16_bf16 v[16:31], v[76:79], v[92:95], v[16:31]
    buffer_load_dwordx4 v[124:127], v230, s[44:47], s42 offen offset:3072 sc1
    ds_read_b64_tr_b16 v[72:73], v239 offset:53248
    ds_read_b64_tr_b16 v[74:75], v239 offset:54272
    ds_read_b64_tr_b16 v[76:77], v240 offset:53248
    ds_read_b64_tr_b16 v[78:79], v240 offset:54272
    s_waitcnt vmcnt(19)
    s_waitcnt lgkmcnt(4)
    v_mfma_f32_32x32x16_bf16 v[0:15], v[64:67], v[96:99], v[0:15]
    v_mfma_f32_32x32x16_bf16 v[16:31], v[68:71], v[96:99], v[16:31]
    s_add_u32 s42, s42, 4096
    buffer_load_dwordx4 v[128:131], v230, s[44:47], s42 offen offset:0 sc1
    ds_read_b64_tr_b16 v[64:65], v239 offset:57344
    ds_read_b64_tr_b16 v[66:67], v239 offset:58368
    ds_read_b64_tr_b16 v[68:69], v240 offset:57344
    ds_read_b64_tr_b16 v[70:71], v240 offset:58368
    s_waitcnt vmcnt(19)
    s_waitcnt lgkmcnt(4)
    v_mfma_f32_32x32x16_bf16 v[0:15], v[72:75], v[100:103], v[0:15]
    v_mfma_f32_32x32x16_bf16 v[16:31], v[76:79], v[100:103], v[16:31]
    buffer_load_dwordx4 v[132:135], v230, s[44:47], s42 offen offset:1024 sc1
    ds_read_b64_tr_b16 v[72:73], v239 offset:61440
    ds_read_b64_tr_b16 v[74:75], v239 offset:62464
    ds_read_b64_tr_b16 v[76:77], v240 offset:61440
    ds_read_b64_tr_b16 v[78:79], v240 offset:62464
    s_waitcnt vmcnt(19)
    s_waitcnt lgkmcnt(4)
    v_mfma_f32_32x32x16_bf16 v[0:15], v[64:67], v[104:107], v[0:15]
    v_mfma_f32_32x32x16_bf16 v[16:31], v[68:71], v[104:107], v[16:31]
    buffer_load_dwordx4 v[136:139], v230, s[44:47], s42 offen offset:2048 sc1
    ds_read_b64_tr_b16 v[64:65], v241 offset:0
    ds_read_b64_tr_b16 v[66:67], v241 offset:1024
    ds_read_b64_tr_b16 v[68:69], v242 offset:0
    ds_read_b64_tr_b16 v[70:71], v242 offset:1024
    s_waitcnt vmcnt(19)
    s_waitcnt lgkmcnt(4)
    v_mfma_f32_32x32x16_bf16 v[0:15], v[72:75], v[108:111], v[0:15]
    v_mfma_f32_32x32x16_bf16 v[16:31], v[76:79], v[108:111], v[16:31]
    buffer_load_dwordx4 v[140:143], v230, s[44:47], s42 offen offset:3072 sc1
    ds_read_b64_tr_b16 v[72:73], v241 offset:4096
    ds_read_b64_tr_b16 v[74:75], v241 offset:5120
    ds_read_b64_tr_b16 v[76:77], v242 offset:4096
    ds_read_b64_tr_b16 v[78:79], v242 offset:5120
    s_waitcnt vmcnt(7)
    s_mov_b64 exec, 1
    ds_add_u32 v233, v234 offset:32
    s_mov_b64 exec, -1
    s_waitcnt lgkmcnt(5)
    v_mfma_f32_32x32x16_bf16 v[0:15], v[64:67], v[112:115], v[0:15]
    v_mfma_f32_32x32x16_bf16 v[16:31], v[68:71], v[112:115], v[16:31]
    s_add_u32 s42, s42, 4096
    buffer_load_dwordx4 v[80:83], v230, s[44:47], s42 offen offset:0 sc1
    ds_read_b64_tr_b16 v[64:65], v241 offset:8192
    ds_read_b64_tr_b16 v[66:67], v241 offset:9216
    ds_read_b64_tr_b16 v[68:69], v242 offset:8192
    ds_read_b64_tr_b16 v[70:71], v242 offset:9216
    s_waitcnt vmcnt(7)
    s_waitcnt lgkmcnt(5)
    v_mfma_f32_32x32x16_bf16 v[0:15], v[72:75], v[116:119], v[0:15]
    v_mfma_f32_32x32x16_bf16 v[16:31], v[76:79], v[116:119], v[16:31]
    buffer_load_dwordx4 v[84:87], v230, s[44:47], s42 offen offset:1024 sc1
    ds_read_b64_tr_b16 v[72:73], v241 offset:12288
    ds_read_b64_tr_b16 v[74:75], v241 offset:13312
    ds_read_b64_tr_b16 v[76:77], v242 offset:12288
    ds_read_b64_tr_b16 v[78:79], v242 offset:13312
    s_waitcnt vmcnt(7)
    s_waitcnt lgkmcnt(4)
    v_mfma_f32_32x32x16_bf16 v[0:15], v[64:67], v[120:123], v[0:15]
    v_mfma_f32_32x32x16_bf16 v[16:31], v[68:71], v[120:123], v[16:31]
    buffer_load_dwordx4 v[88:91], v230, s[44:47], s42 offen offset:2048 sc1
    ds_read_b64_tr_b16 v[64:65], v241 offset:16384
    ds_read_b64_tr_b16 v[66:67], v241 offset:17408
    ds_read_b64_tr_b16 v[68:69], v242 offset:16384
    ds_read_b64_tr_b16 v[70:71], v242 offset:17408
    s_waitcnt vmcnt(7)
    s_waitcnt lgkmcnt(4)
    v_mfma_f32_32x32x16_bf16 v[0:15], v[72:75], v[124:127], v[0:15]
    v_mfma_f32_32x32x16_bf16 v[16:31], v[76:79], v[124:127], v[16:31]
    buffer_load_dwordx4 v[92:95], v230, s[44:47], s42 offen offset:3072 sc1
    ds_read_b64_tr_b16 v[72:73], v241 offset:20480
    ds_read_b64_tr_b16 v[74:75], v241 offset:21504
    ds_read_b64_tr_b16 v[76:77], v242 offset:20480
    ds_read_b64_tr_b16 v[78:79], v242 offset:21504
    s_waitcnt vmcnt(7)
    s_waitcnt lgkmcnt(4)
    v_mfma_f32_32x32x16_bf16 v[0:15], v[64:67], v[128:131], v[0:15]
    v_mfma_f32_32x32x16_bf16 v[16:31], v[68:71], v[128:131], v[16:31]
    global_load_dwordx2 v[208:209], v244, s[18:19] sc1
    s_add_u32 s42, s42, 4096
    buffer_load_dwordx4 v[96:99], v230, s[44:47], s42 offen offset:0 sc1
    ds_read_b64_tr_b16 v[64:65], v241 offset:24576
    ds_read_b64_tr_b16 v[66:67], v241 offset:25600
    ds_read_b64_tr_b16 v[68:69], v242 offset:24576
    ds_read_b64_tr_b16 v[70:71], v242 offset:25600
    s_waitcnt vmcnt(8)
    s_waitcnt lgkmcnt(4)
    v_mfma_f32_32x32x16_bf16 v[0:15], v[72:75], v[132:135], v[0:15]
    v_mfma_f32_32x32x16_bf16 v[16:31], v[76:79], v[132:135], v[16:31]
    buffer_load_dwordx4 v[100:103], v230, s[44:47], s42 offen offset:1024 sc1
    ds_read_b64_tr_b16 v[72:73], v241 offset:28672
    ds_read_b64_tr_b16 v[74:75], v241 offset:29696
    ds_read_b64_tr_b16 v[76:77], v242 offset:28672
    ds_read_b64_tr_b16 v[78:79], v242 offset:29696
    s_waitcnt vmcnt(8)
    s_waitcnt lgkmcnt(4)
    v_mfma_f32_32x32x16_bf16 v[0:15], v[64:67], v[136:139], v[0:15]
    v_mfma_f32_32x32x16_bf16 v[16:31], v[68:71], v[136:139], v[16:31]
    buffer_load_dwordx4 v[104:107], v230, s[44:47], s42 offen offset:2048 sc1
    s_mov_b32 s49, 0
L_SPIN49:
    ds_read_b32 v210, v233 offset:32
    s_waitcnt lgkmcnt(0)
    v_readfirstlane_b32 s48, v210
    s_nop 0
    s_cmp_ge_u32 s48, 4
    s_cbranch_scc1 L_SPUN50
    s_sleep 1
    s_add_u32 s49, s49, 1
    s_cmp_lt_u32 s49, 3200000
    s_cbranch_scc1 L_SPIN49
L_SPUN50:
    ds_read_b64_tr_b16 v[64:65], v239 offset:0
    ds_read_b64_tr_b16 v[66:67], v239 offset:1024
    ds_read_b64_tr_b16 v[68:69], v240 offset:0
    ds_read_b64_tr_b16 v[70:71], v240 offset:1024
    s_waitcnt vmcnt(8)
    v_mfma_f32_32x32x16_bf16 v[0:15], v[72:75], v[140:143], v[0:15]
    v_mfma_f32_32x32x16_bf16 v[16:31], v[76:79], v[140:143], v[16:31]
    buffer_load_dwordx4 v[108:111], v230, s[44:47], s42 offen offset:3072 sc1
    ds_read_b64_tr_b16 v[72:73], v239 offset:4096
    ds_read_b64_tr_b16 v[74:75], v239 offset:5120
    ds_read_b64_tr_b16 v[76:77], v240 offset:4096
    ds_read_b64_tr_b16 v[78:79], v240 offset:5120
    s_waitcnt vmcnt(8)
    s_waitcnt lgkmcnt(4)
    v_mfma_f32_32x32x16_bf16 v[0:15], v[64:67], v[80:83], v[0:15]
    v_mfma_f32_32x32x16_bf16 v[16:31], v[68:71], v[80:83], v[16:31]
    s_add_u32 s42, s42, 4096
    buffer_load_dwordx4 v[112:115], v230, s[44:47], s42 offen offset:0 sc1
    ds_read_b64_tr_b16 v[64:65], v239 offset:8192
    ds_read_b64_tr_b16 v[66:67], v239 offset:9216
    ds_read_b64_tr_b16 v[68:69], v240 offset:8192
    ds_read_b64_tr_b16 v[70:71], v240 offset:9216
    s_waitcnt vmcnt(8)
    s_waitcnt lgkmcnt(4)
    v_mfma_f32_32x32x16_bf16 v[0:15], v[72:75], v[84:87], v[0:15]
    v_mfma_f32_32x32x16_bf16 v[16:31], v[76:79], v[84:87], v[16:31]
    buffer_load_dwordx4 v[116:119], v230, s[44:47], s42 offen offset:1024 sc1
    ds_read_b64_tr_b16 v[72:73], v239 offset:12288
    ds_read_b64_tr_b16 v[74:75], v239 offset:13312
    ds_read_b64_tr_b16 v[76:77], v240 offset:12288
    ds_read_b64_tr_b16 v[78:79], v240 offset:13312
    s_waitcnt vmcnt(8)
    s_waitcnt lgkmcnt(4)
    v_mfma_f32_32x32x16_bf16 v[0:15], v[64:67], v[88:91], v[0:15]
    v_mfma_f32_32x32x16_bf16 v[16:31], v[68:71], v[88:91], v[16:31]
    buffer_load_dwordx4 v[120:123], v230, s[44:47], s42 offen offset:2048 sc1
    ds_read_b64_tr_b16 v[64:65], v239 offset:16384
    ds_read_b64_tr_b16 v[66:67], v239 offset:17408
    ds_read_b64_tr_b16 v[68:69], v240 offset:16384
    ds_read_b64_tr_b16 v[70:71], v240 offset:17408
    s_waitcnt vmcnt(8)
    s_waitcnt lgkmcnt(4)
    v_mfma_f32_32x32x16_bf16 v[0:15], v[72:75], v[92:95], v[0:15]
    v_mfma_f32_32x32x16_bf16 v[16:31], v[76:79], v[92:95], v[16:31]
    buffer_load_dwordx4 v[124:127], v230, s[44:47], s42 offen offset:3072 sc1
    ds_read_b64_tr_b16 v[72:73], v239 offset:20480
    ds_read_b64_tr_b16 v[74:75], v239 offset:21504
    ds_read_b64_tr_b16 v[76:77], v240 offset:20480
    ds_read_b64_tr_b16 v[78:79], v240 offset:21504
    s_waitcnt vmcnt(7)
    s_waitcnt lgkmcnt(4)
    v_mfma_f32_32x32x16_bf16 v[0:15], v[64:67], v[96:99], v[0:15]
    v_mfma_f32_32x32x16_bf16 v[16:31], v[68:71], v[96:99], v[16:31]
    s_mov_b32 s49, 0
    s_branch L_POLC52
L_POLL51:
    global_load_dwordx2 v[208:209], v244, s[18:19] sc1
    s_waitcnt vmcnt(0)
L_POLC52:
    v_cmp_ne_u64 vcc, s[56:57], v[208:209]
    s_nop 0
    s_cmp_eq_u64 vcc, 0
    s_cbranch_scc1 L_POLD53
    s_sleep 4
    s_add_u32 s49, s49, 1
    s_cmp_lt_u32 s49, 200000
    s_cbranch_scc1 L_POLL51
L_POLD53:
    buffer_load_dwordx4 v[128:131], v230, s[44:47], s43 offen offset:0 sc1
    ds_read_b64_tr_b16 v[64:65], v239 offset:24576
    ds_read_b64_tr_b16 v[66:67], v239 offset:25600
    ds_read_b64_tr_b16 v[68:69], v240 offset:24576
    ds_read_b64_tr_b16 v[70:71], v240 offset:25600
    s_waitcnt vmcnt(7)
    s_waitcnt lgkmcnt(4)
    v_mfma_f32_32x32x16_bf16 v[0:15], v[72:75], v[100:103], v[0:15]
    v_mfma_f32_32x32x16_bf16 v[16:31], v[76:79], v[100:103], v[16:31]
    buffer_load_dwordx4 v[132:135], v230, s[44:47], s43 offen offset:1024 sc1
    ds_read_b64_tr_b16 v[72:73], v239 offset:28672
    ds_read_b64_tr_b16 v[74:75], v239 offset:29696
    ds_read_b64_tr_b16 v[76:77], v240 offset:28672
    ds_read_b64_tr_b16 v[78:79], v240 offset:29696
    s_waitcnt vmcnt(7)
    s_waitcnt lgkmcnt(4)
    v_mfma_f32_32x32x16_bf16 v[0:15], v[64:67], v[104:107], v[0:15]
    v_mfma_f32_32x32x16_bf16 v[16:31], v[68:71], v[104:107], v[16:31]
    buffer_load_dwordx4 v[136:139], v230, s[44:47], s43 offen offset:2048 sc1
    ds_read_b64_tr_b16 v[64:65], v239 offset:32768
    ds_read_b64_tr_b16 v[66:67], v239 offset:33792
    ds_read_b64_tr_b16 v[68:69], v240 offset:32768
    ds_read_b64_tr_b16 v[70:71], v240 offset:33792
    s_waitcnt vmcnt(7)
    s_waitcnt lgkmcnt(4)
    v_mfma_f32_32x32x16_bf16 v[0:15], v[72:75], v[108:111], v[0:15]
    v_mfma_f32_32x32x16_bf16 v[16:31], v[76:79], v[108:111], v[16:31]
    buffer_load_dwordx4 v[140:143], v230, s[44:47], s43 offen offset:3072 sc1
    ds_read_b64_tr_b16 v[72:73], v239 offset:36864
    ds_read_b64_tr_b16 v[74:75], v239 offset:37888
    ds_read_b64_tr_b16 v[76:77], v240 offset:36864
    ds_read_b64_tr_b16 v[78:79], v240 offset:37888
    s_waitcnt vmcnt(7)
    s_waitcnt lgkmcnt(4)
    v_mfma_f32_32x32x16_bf16 v[0:15], v[64:67], v[112:115], v[0:15]
    v_mfma_f32_32x32x16_bf16 v[16:31], v[68:71], v[112:115], v[16:31]
    s_add_u32 s43, s43, 4096
    buffer_load_dwordx4 v[80:83], v230, s[44:47], s43 offen offset:0 sc1
    ds_read_b64_tr_b16 v[64:65], v239 offset:40960
    ds_read_b64_tr_b16 v[66:67], v239 offset:41984
    ds_read_b64_tr_b16 v[68:69], v240 offset:40960
    ds_read_b64_tr_b16 v[70:71], v240 offset:41984
    s_waitcnt vmcnt(7)
    s_waitcnt lgkmcnt(4)
    v_mfma_f32_32x32x16_bf16 v[0:15], v[72:75], v[116:119], v[0:15]
    v_mfma_f32_32x32x16_bf16 v[16:31], v[76:79], v[116:119], v[16:31]
    buffer_load_dwordx4 v[84:87], v230, s[44:47], s43 offen offset:1024 sc1
    ds_read_b64_tr_b16 v[72:73], v239 offset:45056
    ds_read_b64_tr_b16 v[74:75], v239 offset:46080
    ds_read_b64_tr_b16 v[76:77], v240 offset:45056
    ds_read_b64_tr_b16 v[78:79], v240 offset:46080
    s_waitcnt vmcnt(7)
    s_waitcnt lgkmcnt(4)
    v_mfma_f32_32x32x16_bf16 v[0:15], v[64:67], v[120:123], v[0:15]
    v_mfma_f32_32x32x16_bf16 v[16:31], v[68:71], v[120:123], v[16:31]
    buffer_load_dwordx4 v[88:91], v230, s[44:47], s43 offen offset:2048 sc1
    ds_read_b64_tr_b16 v[64:65], v241 offset:32768
    ds_read_b64_tr_b16 v[66:67], v241 offset:33792
    ds_read_b64_tr_b16 v[68:69], v242 offset:32768
    ds_read_b64_tr_b16 v[70:71], v242 offset:33792
    s_waitcnt vmcnt(7)
    s_waitcnt lgkmcnt(4)
    v_mfma_f32_32x32x16_bf16 v[0:15], v[72:75], v[124:127], v[0:15]
    v_mfma_f32_32x32x16_bf16 v[16:31], v[76:79], v[124:127], v[16:31]
    buffer_load_dwordx4 v[92:95], v230, s[44:47], s43 offen offset:3072 sc1
    ds_read_b64_tr_b16 v[72:73], v241 offset:36864
    ds_read_b64_tr_b16 v[74:75], v241 offset:37888
    ds_read_b64_tr_b16 v[76:77], v242 offset:36864
    ds_read_b64_tr_b16 v[78:79], v242 offset:37888
    s_waitcnt vmcnt(7)
    s_waitcnt lgkmcnt(4)
    v_mfma_f32_32x32x16_bf16 v[32:47], v[64:67], v[128:131], 0
    v_mfma_f32_32x32x16_bf16 v[48:63], v[68:71], v[128:131], 0
    s_mov_b32 s49, 0
L_SPIN54:
    ds_read_b32 v210, v233 offset:48
    s_waitcnt lgkmcnt(0)
    v_readfirstlane_b32 s48, v210
    s_nop 0
    s_cmp_ge_u32 s48, 4
    s_cbranch_scc1 L_SPUN55
    s_sleep 1
    s_add_u32 s49, s49, 1
    s_cmp_lt_u32 s49, 3200000
    s_cbranch_scc1 L_SPIN54
L_SPUN55:
    ds_write_b128 v245, v[0:3] offset:0
    ds_write_b128 v245, v[4:7] offset:1024
    ds_write_b128 v245, v[8:11] offset:2048
    ds_write_b128 v245, v[12:15] offset:3072
    ds_write_b128 v245, v[16:19] offset:4096
    ds_write_b128 v245, v[20:23] offset:5120
    ds_write_b128 v245, v[24:27] offset:6144
    ds_write_b128 v245, v[28:31] offset:7168
    s_mov_b64 exec, 1
    ds_add_u32 v233, v234 offset:36
    s_mov_b64 exec, -1
    s_add_u32 s43, s43, 4096
    buffer_load_dwordx4 v[96:99], v230, s[44:47], s43 offen offset:0 sc1
    buffer_load_dwordx4 v[100:103], v230, s[44:47], s43 offen offset:1024 sc1
    ds_read_b64_tr_b16 v[64:65], v241 offset:40960
    ds_read_b64_tr_b16 v[66:67], v241 offset:41984
    ds_read_b64_tr_b16 v[68:69], v242 offset:40960
    ds_read_b64_tr_b16 v[70:71], v242 offset:41984
    s_waitcnt vmcnt(8)
    v_mfma_f32_32x32x16_bf16 v[32:47], v[72:75], v[132:135], v[32:47]
    v_mfma_f32_32x32x16_bf16 v[48:63], v[76:79], v[132:135], v[48:63]
    buffer_load_dwordx4 v[104:107], v230, s[44:47], s43 offen offset:2048 sc1
    buffer_load_dwordx4 v[108:111], v230, s[44:47], s43 offen offset:3072 sc1
    ds_read_b64_tr_b16 v[72:73], v241 offset:45056
    ds_read_b64_tr_b16 v[74:75], v241 offset:46080
    ds_read_b64_tr_b16 v[76:77], v242 offset:45056
    ds_read_b64_tr_b16 v[78:79], v242 offset:46080
    s_waitcnt vmcnt(9)
    s_waitcnt lgkmcnt(4)
    v_mfma_f32_32x32x16_bf16 v[32:47], v[64:67], v[136:139], v[32:47]
    v_mfma_f32_32x32x16_bf16 v[48:63], v[68:71], v[136:139], v[48:63]
    s_add_u32 s43, s43, 4096
    buffer_load_dwordx4 v[112:115], v230, s[44:47], s43 offen offset:0 sc1
    buffer_load_dwordx4 v[116:119], v230, s[44:47], s43 offen offset:1024 sc1
    ds_read_b64_tr_b16 v[64:65], v239 offset:49152
    ds_read_b64_tr_b16 v[66:67], v239 offset:50176
    ds_read_b64_tr_b16 v[68:69], v240 offset:49152
    ds_read_b64_tr_b16 v[70:71], v240 offset:50176
    s_waitcnt vmcnt(10)
    s_waitcnt lgkmcnt(4)
    v_mfma_f32_32x32x16_bf16 v[32:47], v[72:75], v[140:143], v[32:47]
    v_mfma_f32_32x32x16_bf16 v[48:63], v[76:79], v[140:143], v[48:63]
    buffer_load_dwordx4 v[120:123], v230, s[44:47], s43 offen offset:2048 sc1
    buffer_load_dwordx4 v[124:127], v230, s[44:47], s43 offen offset:3072 sc1
    ds_read_b64_tr_b16 v[72:73], v239 offset:53248
    ds_read_b64_tr_b16 v[74:75], v239 offset:54272
    ds_read_b64_tr_b16 v[76:77], v240 offset:53248
    ds_read_b64_tr_b16 v[78:79], v240 offset:54272
    s_waitcnt vmcnt(11)
    s_waitcnt lgkmcnt(4)
    v_mfma_f32_32x32x16_bf16 v[32:47], v[64:67], v[80:83], v[32:47]
    v_mfma_f32_32x32x16_bf16 v[48:63], v[68:71], v[80:83], v[48:63]
    s_add_u32 s43, s43, 4096
    buffer_load_dwordx4 v[128:131], v230, s[44:47], s43 offen offset:0 sc1
    buffer_load_dwordx4 v[132:135], v230, s[44:47], s43 offen offset:1024 sc1
    ds_read_b64_tr_b16 v[64:65], v239 offset:57344
    ds_read_b64_tr_b16 v[66:67], v239 offset:58368
    ds_read_b64_tr_b16 v[68:69], v240 offset:57344
    ds_read_b64_tr_b16 v[70:71], v240 offset:58368
    s_waitcnt vmcnt(12)
    s_waitcnt lgkmcnt(4)
    v_mfma_f32_32x32x16_bf16 v[32:47], v[72:75], v[84:87], v[32:47]
    v_mfma_f32_32x32x16_bf16 v[48:63], v[76:79], v[84:87], v[48:63]
    buffer_load_dwordx4 v[136:139], v230, s[44:47], s43 offen offset:2048 sc1
    buffer_load_dwordx4 v[140:143], v230, s[44:47], s43 offen offset:3072 sc1
    ds_read_b64_tr_b16 v[72:73], v239 offset:61440
    ds_read_b64_tr_b16 v[74:75], v239 offset:62464
    ds_read_b64_tr_b16 v[76:77], v240 offset:61440
    ds_read_b64_tr_b16 v[78:79], v240 offset:62464
    s_waitcnt vmcnt(13)
    s_waitcnt lgkmcnt(4)
    v_mfma_f32_32x32x16_bf16 v[32:47], v[64:67], v[88:91], v[32:47]
    v_mfma_f32_32x32x16_bf16 v[48:63], v[68:71], v[88:91], v[48:63]
    s_add_u32 s43, s43, 4096
    buffer_load_dwordx4 v[80:83], v230, s[44:47], s43 offen offset:0 sc1
    buffer_load_dwordx4 v[84:87], v230, s[44:47], s43 offen offset:1024 sc1
    ds_read_b64_tr_b16 v[64:65], v241 offset:0
    ds_read_b64_tr_b16 v[66:67], v241 offset:1024
    ds_read_b64_tr_b16 v[68:69], v242 offset:0
    ds_read_b64_tr_b16 v[70:71], v242 offset:1024
    s_waitcnt vmcnt(14)
    s_waitcnt lgkmcnt(4)
    v_mfma_f32_32x32x16_bf16 v[32:47], v[72:75], v[92:95], v[32:47]
    v_mfma_f32_32x32x16_bf16 v[48:63], v[76:79], v[92:95], v[48:63]
    buffer_load_dwordx4 v[88:91], v230, s[44:47], s43 offen offset:2048 sc1
    buffer_load_dwordx4 v[92:95], v230, s[44:47], s43 offen offset:3072 sc1
    ds_read_b64_tr_b16 v[72:73], v241 offset:4096
    ds_read_b64_tr_b16 v[74:75], v241 offset:5120
    ds_read_b64_tr_b16 v[76:77], v242 offset:4096
    ds_read_b64_tr_b16 v[78:79], v242 offset:5120
    s_waitcnt vmcnt(15)
    s_waitcnt lgkmcnt(4)
    v_mfma_f32_32x32x16_bf16 v[32:47], v[64:67], v[96:99], v[32:47]
    v_mfma_f32_32x32x16_bf16 v[48:63], v[68:71], v[96:99], v[48:63]
    s_add_u32 s43, s43, 4096
    buffer_load_dwordx4 v[96:99], v230, s[44:47], s43 offen offset:0 sc1
    ds_read_b64_tr_b16 v[64:65], v241 offset:8192
    ds_read_b64_tr_b16 v[66:67], v241 offset:9216
    ds_read_b64_tr_b16 v[68:69], v242 offset:8192
    ds_read_b64_tr_b16 v[70:71], v242 offset:9216
    s_waitcnt vmcnt(15)
    s_waitcnt lgkmcnt(4)
    v_mfma_f32_32x32x16_bf16 v[32:47], v[72:75], v[100:103], v[32:47]
    v_mfma_f32_32x32x16_bf16 v[48:63], v[76:79], v[100:103], v[48:63]
    buffer_load_dwordx4 v[100:103], v230, s[44:47], s43 offen offset:1024 sc1
    ds_read_b64_tr_b16 v[72:73], v241 offset:12288
    ds_read_b64_tr_b16 v[74:75], v241 offset:13312
    ds_read_b64_tr_b16 v[76:77], v242 offset:12288
    ds_read_b64_tr_b16 v[78:79], v242 offset:13312
    s_waitcnt vmcnt(15)
    s_waitcnt lgkmcnt(4)
    v_mfma_f32_32x32x16_bf16 v[32:47], v[64:67], v[104:107], v[32:47]
    v_mfma_f32_32x32x16_bf16 v[48:63], v[68:71], v[104:107], v[48:63]
    buffer_load_dwordx4 v[104:107], v230, s[44:47], s43 offen offset:2048 sc1
    ds_read_b64_tr_b16 v[64:65], v241 offset:16384
    ds_read_b64_tr_b16 v[66:67], v241 offset:17408
    ds_read_b64_tr_b16 v[68:69], v242 offset:16384
    ds_read_b64_tr_b16 v[70:71], v242 offset:17408
    s_waitcnt vmcnt(15)
    s_waitcnt lgkmcnt(4)
    v_mfma_f32_32x32x16_bf16 v[32:47], v[72:75], v[108:111], v[32:47]
    v_mfma_f32_32x32x16_bf16 v[48:63], v[76:79], v[108:111], v[48:63]
    buffer_load_dwordx4 v[108:111], v230, s[44:47], s43 offen offset:3072 sc1
    s_mov_b64 exec, 1
    ds_add_u32 v233, v234 offset:52
    s_mov_b64 exec, -1
    ds_read_b64_tr_b16 v[72:73], v241 offset:20480
    ds_read_b64_tr_b16 v[74:75], v241 offset:21504
    ds_read_b64_tr_b16 v[76:77], v242 offset:20480
    ds_read_b64_tr_b16 v[78:79], v242 offset:21504
    s_waitcnt vmcnt(15)
    s_waitcnt lgkmcnt(5)
    v_mfma_f32_32x32x16_bf16 v[32:47], v[64:67], v[112:115], v[32:47]
    v_mfma_f32_32x32x16_bf16 v[48:63], v[68:71], v[112:115], v[48:63]
    ds_read_b64_tr_b16 v[64:65], v241 offset:24576
    ds_read_b64_tr_b16 v[66:67], v241 offset:25600
    ds_read_b64_tr_b16 v[68:69], v242 offset:24576
    ds_read_b64_tr_b16 v[70:71], v242 offset:25600
    s_waitcnt vmcnt(14)
    s_waitcnt lgkmcnt(4)
    v_mfma_f32_32x32x16_bf16 v[32:47], v[72:75], v[116:119], v[32:47]
    v_mfma_f32_32x32x16_bf16 v[48:63], v[76:79], v[116:119], v[48:63]
    ds_read_b64_tr_b16 v[72:73], v241 offset:28672
    ds_read_b64_tr_b16 v[74:75], v241 offset:29696
    ds_read_b64_tr_b16 v[76:77], v242 offset:28672
    ds_read_b64_tr_b16 v[78:79], v242 offset:29696
    s_waitcnt vmcnt(13)
    s_waitcnt lgkmcnt(4)
    v_mfma_f32_32x32x16_bf16 v[32:47], v[64:67], v[120:123], v[32:47]
    v_mfma_f32_32x32x16_bf16 v[48:63], v[68:71], v[120:123], v[48:63]
    ds_read_b64_tr_b16 v[64:65], v239 offset:0
    ds_read_b64_tr_b16 v[66:67], v239 offset:1024
    ds_read_b64_tr_b16 v[68:69], v240 offset:0
    ds_read_b64_tr_b16 v[70:71], v240 offset:1024
    s_waitcnt vmcnt(12)
    s_waitcnt lgkmcnt(4)
    v_mfma_f32_32x32x16_bf16 v[32:47], v[72:75], v[124:127], v[32:47]
    v_mfma_f32_32x32x16_bf16 v[48:63], v[76:79], v[124:127], v[48:63]
    ds_read_b64_tr_b16 v[72:73], v239 offset:4096
    ds_read_b64_tr_b16 v[74:75], v239 offset:5120
    ds_read_b64_tr_b16 v[76:77], v240 offset:4096
    ds_read_b64_tr_b16 v[78:79], v240 offset:5120
    s_waitcnt vmcnt(11)
    s_waitcnt lgkmcnt(4)
    v_mfma_f32_32x32x16_bf16 v[32:47], v[64:67], v[128:131], v[32:47]
    v_mfma_f32_32x32x16_bf16 v[48:63], v[68:71], v[128:131], v[48:63]
    s_mov_b64 exec, 1
    ds_add_u32 v233, v234 offset:40
    s_mov_b64 exec, -1
    ds_read_b64_tr_b16 v[64:65], v239 offset:8192
    ds_read_b64_tr_b16 v[66:67], v239 offset:9216
    ds_read_b64_tr_b16 v[68:69], v240 offset:8192
    ds_read_b64_tr_b16 v[70:71], v240 offset:9216
    s_waitcnt vmcnt(10)
    s_waitcnt lgkmcnt(5)
    v_mfma_f32_32x32x16_bf16 v[32:47], v[72:75], v[132:135], v[32:47]
    v_mfma_f32_32x32x16_bf16 v[48:63], v[76:79], v[132:135], v[48:63]
    ds_read_b64_tr_b16 v[72:73], v239 offset:12288
    ds_read_b64_tr_b16 v[74:75], v239 offset:13312
    ds_read_b64_tr_b16 v[76:77], v240 offset:12288
    ds_read_b64_tr_b16 v[78:79], v240 offset:13312
    s_waitcnt vmcnt(9)
    s_waitcnt lgkmcnt(4)
    v_mfma_f32_32x32x16_bf16 v[32:47], v[64:67], v[136:139], v[32:47]
    v_mfma_f32_32x32x16_bf16 v[48:63], v[68:71], v[136:139], v[48:63]
    ds_read_b64_tr_b16 v[64:65], v239 offset:16384
    ds_read_b64_tr_b16 v[66:67], v239 offset:17408
    ds_read_b64_tr_b16 v[68:69], v240 offset:16384
    ds_read_b64_tr_b16 v[70:71], v240 offset:17408
    s_waitcnt vmcnt(8)
    s_waitcnt lgkmcnt(4)
    v_mfma_f32_32x32x16_bf16 v[32:47], v[72:75], v[140:143], v[32:47]
    v_mfma_f32_32x32x16_bf16 v[48:63], v[76:79], v[140:143], v[48:63]
    ds_read_b64_tr_b16 v[72:73], v239 offset:20480
    ds_read_b64_tr_b16 v[74:75], v239 offset:21504
    ds_read_b64_tr_b16 v[76:77], v240 offset:20480
    ds_read_b64_tr_b16 v[78:79], v240 offset:21504
    s_waitcnt vmcnt(7)
    s_waitcnt lgkmcnt(4)
    v_mfma_f32_32x32x16_bf16 v[32:47], v[64:67], v[80:83], v[32:47]
    v_mfma_f32_32x32x16_bf16 v[48:63], v[68:71], v[80:83], v[48:63]
    ds_read_b64_tr_b16 v[64:65], v239 offset:24576
    ds_read_b64_tr_b16 v[66:67], v239 offset:25600
    ds_read_b64_tr_b16 v[68:69], v240 offset:24576
    ds_read_b64_tr_b16 v[70:71], v240 offset:25600
    s_waitcnt vmcnt(6)
    s_waitcnt lgkmcnt(4)
    v_mfma_f32_32x32x16_bf16 v[32:47], v[72:75], v[84:87], v[32:47]
    v_mfma_f32_32x32x16_bf16 v[48:63], v[76:79], v[84:87], v[48:63]
    ds_read_b64_tr_b16 v[72:73], v239 offset:28672
    ds_read_b64_tr_b16 v[74:75], v239 offset:29696
    ds_read_b64_tr_b16 v[76:77], v240 offset:28672
    ds_read_b64_tr_b16 v[78:79], v240 offset:29696
    s_waitcnt vmcnt(5)
    s_waitcnt lgkmcnt(4)
    v_mfma_f32_32x32x16_bf16 v[32:47], v[64:67], v[88:91], v[32:47]
    v_mfma_f32_32x32x16_bf16 v[48:63], v[68:71], v[88:91], v[48:63]
    global_load_dwordx4 v[212:215], v247, s[18:19] offset:0 sc1
    global_load_dwordx4 v[216:219], v247, s[18:19] offset:1024 sc1
    global_load_dwordx4 v[220:223], v247, s[18:19] offset:2048 sc1
    ds_read_b64_tr_b16 v[64:65], v239 offset:32768
    ds_read_b64_tr_b16 v[66:67], v239 offset:33792
    ds_read_b64_tr_b16 v[68:69], v240 offset:32768
    ds_read_b64_tr_b16 v[70:71], v240 offset:33792
    s_waitcnt vmcnt(7)
    s_waitcnt lgkmcnt(4)
    v_mfma_f32_32x32x16_bf16 v[32:47], v[72:75], v[92:95], v[32:47]
    v_mfma_f32_32x32x16_bf16 v[48:63], v[76:79], v[92:95], v[48:63]
    ds_read_b64_tr_b16 v[72:73], v239 offset:36864
    ds_read_b64_tr_b16 v[74:75], v239 offset:37888
    ds_read_b64_tr_b16 v[76:77], v240 offset:36864
    ds_read_b64_tr_b16 v[78:79], v240 offset:37888
    s_waitcnt vmcnt(6)
    s_waitcnt lgkmcnt(4)
    v_mfma_f32_32x32x16_bf16 v[32:47], v[64:67], v[96:99], v[32:47]
    v_mfma_f32_32x32x16_bf16 v[48:63], v[68:71], v[96:99], v[48:63]
    ds_read_b64_tr_b16 v[64:65], v239 offset:40960
    ds_read_b64_tr_b16 v[66:67], v239 offset:41984
    ds_read_b64_tr_b16 v[68:69], v240 offset:40960
    ds_read_b64_tr_b16 v[70:71], v240 offset:41984
    s_waitcnt vmcnt(5)
    s_waitcnt lgkmcnt(4)
    v_mfma_f32_32x32x16_bf16 v[32:47], v[72:75], v[100:103], v[32:47]
    v_mfma_f32_32x32x16_bf16 v[48:63], v[76:79], v[100:103], v[48:63]
    ds_read_b64_tr_b16 v[72:73], v239 offset:45056
    ds_read_b64_tr_b16 v[74:75], v239 offset:46080
    ds_read_b64_tr_b16 v[76:77], v240 offset:45056
    ds_read_b64_tr_b16 v[78:79], v240 offset:46080
    s_waitcnt vmcnt(4)
    s_waitcnt lgkmcnt(4)
    v_mfma_f32_32x32x16_bf16 v[32:47], v[64:67], v[104:107], v[32:47]
    v_mfma_f32_32x32x16_bf16 v[48:63], v[68:71], v[104:107], v[48:63]
    s_waitcnt vmcnt(3)
    s_waitcnt lgkmcnt(0)
    v_mfma_f32_32x32x16_bf16 v[32:47], v[72:75], v[108:111], v[32:47]
    v_mfma_f32_32x32x16_bf16 v[48:63], v[76:79], v[108:111], v[48:63]
    s_mov_b32 s49, 0
L_PCHK:
    s_waitcnt vmcnt(0)
    v_xor_b32 v215, s56, v215
    v_xor_b32 v219, s56, v219
    v_xor_b32 v223, s56, v223
    v_or3_b32 v210, v215, v219, v223
    v_cmp_ne_u32 vcc, 0, v210
    s_nop 0
    s_cmp_eq_u64 vcc, 0
    s_cbranch_scc1 L_POK
    s_add_u32 s49, s49, 1
    s_cmp_ge_u32 s49, 200000
    s_cbranch_scc1 L_POK
    s_sleep 4
    global_load_dwordx4 v[212:215], v247, s[18:19] offset:0 sc1
    global_load_dwordx4 v[216:219], v247, s[18:19] offset:1024 sc1
    global_load_dwordx4 v[220:223], v247, s[18:19] offset:2048 sc1
    s_branch L_PCHK
L_POK:
    v_lshlrev_b32 v0, 16, v212
    v_and_b32 v1, 0xffff0000, v212
    v_lshlrev_b32 v2, 16, v213
    v_and_b32 v3, 0xffff0000, v213
    v_lshlrev_b32 v4, 16, v214
    v_and_b32 v5, 0xffff0000, v214
    v_lshlrev_b32 v6, 16, v216
    v_and_b32 v7, 0xffff0000, v216
    v_lshlrev_b32 v8, 16, v217
    v_and_b32 v9, 0xffff0000, v217
    v_lshlrev_b32 v10, 16, v218
    v_and_b32 v11, 0xffff0000, v218
    v_lshlrev_b32 v12, 16, v220
    v_and_b32 v13, 0xffff0000, v220
    v_lshlrev_b32 v14, 16, v221
    v_and_b32 v15, 0xffff0000, v221
    s_cmp_eq_u32 s55, 0
    s_cbranch_scc1 L_PADD0
    v_add_f32 v48, v48, v0
    v_add_f32 v49, v49, v1
    v_add_f32 v50, v50, v2
    v_add_f32 v51, v51, v3
    v_add_f32 v52, v52, v4
    v_add_f32 v53, v53, v5
    v_add_f32 v54, v54, v6
    v_add_f32 v55, v55, v7
    v_add_f32 v56, v56, v8
    v_add_f32 v57, v57, v9
    v_add_f32 v58, v58, v10
    v_add_f32 v59, v59, v11
    v_add_f32 v60, v60, v12
    v_add_f32 v61, v61, v13
    v_add_f32 v62, v62, v14
    v_add_f32 v63, v63, v15
    s_branch L_PADD1
L_PADD0:
    v_add_f32 v32, v32, v0
    v_add_f32 v33, v33, v1
    v_add_f32 v34, v34, v2
    v_add_f32 v35, v35, v3
    v_add_f32 v36, v36, v4
    v_add_f32 v37, v37, v5
    v_add_f32 v38, v38, v6
    v_add_f32 v39, v39, v7
    v_add_f32 v40, v40, v8
    v_add_f32 v41, v41, v9
    v_add_f32 v42, v42, v10
    v_add_f32 v43, v43, v11
    v_add_f32 v44, v44, v12
    v_add_f32 v45, v45, v13
    v_add_f32 v46, v46, v14
    v_add_f32 v47, v47, v15
L_PADD1:
    s_mov_b32 s49, 0
L_SPIN56:
    ds_read_b32 v210, v233 offset:40
    s_waitcnt lgkmcnt(0)
    v_readfirstlane_b32 s48, v210
    s_nop 0
    s_cmp_ge_u32 s48, 4
    s_cbranch_scc1 L_SPUN57
    s_sleep 1
    s_add_u32 s49, s49, 1
    s_cmp_lt_u32 s49, 3200000
    s_cbranch_scc1 L_SPIN56
L_SPUN57:
    ds_write_b128 v246, v[32:35] offset:0
    ds_write_b128 v246, v[36:39] offset:1088
    ds_write_b128 v246, v[40:43] offset:2176
    ds_write_b128 v246, v[44:47] offset:3264
    ds_write_b128 v246, v[48:51] offset:4352
    ds_write_b128 v246, v[52:55] offset:5440
    ds_write_b128 v246, v[56:59] offset:6528
    ds_write_b128 v246, v[60:63] offset:7616
    v_mov_b32 v0, v232
    s_branch L_FINAL
L_SPC:
    s_mov_b64 exec, 1
    ds_add_u32 v233, v234 offset:44
    s_mov_b64 exec, -1
    s_lshl_b32 s48, s23, 11
    s_add_u32 s48, s48, 98304
    v_lshl_add_u32 v40, v0, 4, s48
    s_lshl_b32 s48, s21, 18
    s_lshl_b32 s49, s23, 16
    s_add_u32 s48, s48, s49
    s_lshl_b32 s49, s22, 7
    s_sub_u32 s48, s48, s49
    s_add_u32 s48, s48, 8392576
    v_and_b32 v41, 7, v0
    v_lshrrev_b32 v42, 4, v0
    v_xor_b32 v41, v41, v42
    v_xor_b32 v41, 7, v41
    v_lshlrev_b32 v41, 4, v41
    v_lshrrev_b32 v42, 3, v0
    v_lshl_add_u32 v41, v42, 12, v41
    v_add_u32 v41, s48, v41
    v_xor_b32 v42, 64, v41
    v_add_u32 v42, 32768, v42
    s_mov_b32 s49, 0
L_SPIN58:
    ds_read_b32 v1, v233 offset:44
    s_waitcnt lgkmcnt(0)
    v_readfirstlane_b32 s48, v1
    s_nop 0
    s_cmp_ge_u32 s48, 4
    s_cbranch_scc1 L_SPUN59
    s_sleep 1
    s_add_u32 s49, s49, 1
    s_cmp_lt_u32 s49, 3200000
    s_cbranch_scc1 L_SPIN58
L_SPUN59:
    ds_read_b128 v[44:47], v40
    ds_read_b128 v[48:51], v40 offset:1024
    s_waitcnt lgkmcnt(0)
    global_store_dwordx4 v41, v[44:47], s[18:19] sc1
    global_store_dwordx4 v42, v[48:51], s[18:19] sc1
    s_load_dwordx2 s[56:57], s[62:63], 0
    s_lshl_b32 s48, s16, 1
    s_add_u32 s48, s48, s3
    s_lshl_b32 s48, s48, 2
    s_add_u32 s50, s48, s20
    s_lshl_b32 s49, s50, 14
    s_add_u32 s32, s4, s49
    s_addc_u32 s33, s5, 0
    s_mov_b32 s34, 16384
    s_mov_b32 s35, 0x00020000
    s_lshl_b32 s50, s50, 6
    s_add_u32 s50, s50, 12582912
    v_mov_b32 v10, s50
    s_waitcnt vmcnt(0)
    s_waitcnt lgkmcnt(0)
    s_cmp_lg_u32 s56, 0
    s_cbranch_scc1 L_TAGD61
    s_mov_b32 s49, 0
    v_mov_b32 v54, 0
L_TAG60:
    s_sleep 8
    global_load_dwordx2 v[52:53], v54, s[62:63] sc1
    s_waitcnt vmcnt(0)
    v_readfirstlane_b32 s56, v52
    v_readfirstlane_b32 s57, v53
    s_add_u32 s49, s49, 1
    s_cmp_lt_u32 s49, 200000
    s_cselect_b32 s48, s56, 1
    s_cmp_eq_u32 s48, 0
    s_cbranch_scc1 L_TAG60
    s_nop 4
L_TAGD61:
    s_mov_b64 exec, 1
    ds_add_rtn_u32 v52, v233, v234 offset:0
    s_mov_b64 exec, -1
    s_waitcnt lgkmcnt(0)
    v_readfirstlane_b32 s48, v52
    s_nop 0
    s_cmp_lg_u32 s48, 3
    s_cbranch_scc1 L_NOF62
    s_lshl_b32 s48, s59, 7
    s_add_u32 s48, s48, 12648448
    v_mov_b32 v54, s48
    v_mov_b32 v52, s56
    v_mov_b32 v53, s57
    s_mov_b64 exec, 1
    global_store_dwordx2 v54, v[52:53], s[18:19] sc1
    s_mov_b64 exec, -1
L_NOF62:
    s_barrier
    global_load_dwordx4 v[80:83], v230, s[30:31]
    s_mov_b32 s49, 0
    buffer_load_dwordx4 v[100:103], v230, s[32:35], s49 offen offset:0
    buffer_load_dwordx4 v[104:107], v230, s[32:35], s49 offen offset:1024
    buffer_load_dwordx4 v[108:111], v230, s[32:35], s49 offen offset:2048
    buffer_load_dwordx4 v[112:115], v230, s[32:35], s49 offen offset:3072
    s_mov_b32 s49, 4096
    buffer_load_dwordx4 v[116:119], v230, s[32:35], s49 offen offset:0
    buffer_load_dwordx4 v[120:123], v230, s[32:35], s49 offen offset:1024
    buffer_load_dwordx4 v[124:127], v230, s[32:35], s49 offen offset:2048
    buffer_load_dwordx4 v[128:131], v230, s[32:35], s49 offen offset:3072
    s_mov_b32 s49, 8192
    buffer_load_dwordx4 v[132:135], v230, s[32:35], s49 offen offset:0
    buffer_load_dwordx4 v[136:139], v230, s[32:35], s49 offen offset:1024
    buffer_load_dwordx4 v[140:143], v230, s[32:35], s49 offen offset:2048
    buffer_load_dwordx4 v[144:147], v230, s[32:35], s49 offen offset:3072
    s_mov_b32 s49, 12288
    buffer_load_dwordx4 v[148:151], v230, s[32:35], s49 offen offset:0
    buffer_load_dwordx4 v[152:155], v230, s[32:35], s49 offen offset:1024
    buffer_load_dwordx4 v[156:159], v230, s[32:35], s49 offen offset:2048
    buffer_load_dwordx4 v[160:163], v230, s[32:35], s49 offen offset:3072
    s_barrier
    s_waitcnt vmcnt(0)
    v_dot2_f32_bf16 v84, v100, v80, 0
    v_dot2_f32_bf16 v85, v104, v80, 0
    v_dot2_f32_bf16 v86, v108, v80, 0
    v_dot2_f32_bf16 v87, v112, v80, 0
    v_dot2_f32_bf16 v88, v116, v80, 0
    v_dot2_f32_bf16 v89, v120, v80, 0
    v_dot2_f32_bf16 v90, v124, v80, 0
    v_dot2_f32_bf16 v91, v128, v80, 0
    v_dot2_f32_bf16 v92, v132, v80, 0
    v_dot2_f32_bf16 v93, v136, v80, 0
    v_dot2_f32_bf16 v94, v140, v80, 0
    v_dot2_f32_bf16 v95, v144, v80, 0
    v_dot2_f32_bf16 v96, v148, v80, 0
    v_dot2_f32_bf16 v97, v152, v80, 0
    v_dot2_f32_bf16 v98, v156, v80, 0
    v_dot2_f32_bf16 v99, v160, v80, 0
    v_dot2_f32_bf16 v84, v101, v81, v84
    v_dot2_f32_bf16 v85, v105, v81, v85
    v_dot2_f32_bf16 v86, v109, v81, v86
    v_dot2_f32_bf16 v87, v113, v81, v87
    v_dot2_f32_bf16 v88, v117, v81, v88
    v_dot2_f32_bf16 v89, v121, v81, v89
    v_dot2_f32_bf16 v90, v125, v81, v90
    v_dot2_f32_bf16 v91, v129, v81, v91
    v_dot2_f32_bf16 v92, v133, v81, v92
    v_dot2_f32_bf16 v93, v137, v81, v93
    v_dot2_f32_bf16 v94, v141, v81, v94
    v_dot2_f32_bf16 v95, v145, v81, v95
    v_dot2_f32_bf16 v96, v149, v81, v96
    v_dot2_f32_bf16 v97, v153, v81, v97
    v_dot2_f32_bf16 v98, v157, v81, v98
    v_dot2_f32_bf16 v99, v161, v81, v99
    v_dot2_f32_bf16 v84, v102, v82, v84
    v_dot2_f32_bf16 v85, v106, v82, v85
    v_dot2_f32_bf16 v86, v110, v82, v86
    v_dot2_f32_bf16 v87, v114, v82, v87
    v_dot2_f32_bf16 v88, v118, v82, v88
    v_dot2_f32_bf16 v89, v122, v82, v89
    v_dot2_f32_bf16 v90, v126, v82, v90
    v_dot2_f32_bf16 v91, v130, v82, v91
    v_dot2_f32_bf16 v92, v134, v82, v92
    v_dot2_f32_bf16 v93, v138, v82, v93
    v_dot2_f32_bf16 v94, v142, v82, v94
    v_dot2_f32_bf16 v95, v146, v82, v95
    v_dot2_f32_bf16 v96, v150, v82, v96
    v_dot2_f32_bf16 v97, v154, v82, v97
    v_dot2_f32_bf16 v98, v158, v82, v98
    v_dot2_f32_bf16 v99, v162, v82, v99
    v_dot2_f32_bf16 v84, v103, v83, v84
    v_dot2_f32_bf16 v85, v107, v83, v85
    v_dot2_f32_bf16 v86, v111, v83, v86
    v_dot2_f32_bf16 v87, v115, v83, v87
    v_dot2_f32_bf16 v88, v119, v83, v88
    v_dot2_f32_bf16 v89, v123, v83, v89
    v_dot2_f32_bf16 v90, v127, v83, v90
    v_dot2_f32_bf16 v91, v131, v83, v91
    v_dot2_f32_bf16 v92, v135, v83, v92
    v_dot2_f32_bf16 v93, v139, v83, v93
    v_dot2_f32_bf16 v94, v143, v83, v94
    v_dot2_f32_bf16 v95, v147, v83, v95
    v_dot2_f32_bf16 v96, v151, v83, v96
    v_dot2_f32_bf16 v97, v155, v83, v97
    v_dot2_f32_bf16 v98, v159, v83, v98
    v_dot2_f32_bf16 v99, v163, v83, v99
    v_add_f32_dpp v84, v84, v84 quad_perm:[1,0,3,2] row_mask:0xf bank_mask:0xf
    v_add_f32_dpp v85, v85, v85 quad_perm:[1,0,3,2] row_mask:0xf bank_mask:0xf
    v_add_f32_dpp v86, v86, v86 quad_perm:[1,0,3,2] row_mask:0xf bank_mask:0xf
    v_add_f32_dpp v87, v87, v87 quad_perm:[1,0,3,2] row_mask:0xf bank_mask:0xf
    v_add_f32_dpp v88, v88, v88 quad_perm:[1,0,3,2] row_mask:0xf bank_mask:0xf
    v_add_f32_dpp v89, v89, v89 quad_perm:[1,0,3,2] row_mask:0xf bank_mask:0xf
    v_add_f32_dpp v90, v90, v90 quad_perm:[1,0,3,2] row_mask:0xf bank_mask:0xf
    v_add_f32_dpp v91, v91, v91 quad_perm:[1,0,3,2] row_mask:0xf bank_mask:0xf
    v_add_f32_dpp v92, v92, v92 quad_perm:[1,0,3,2] row_mask:0xf bank_mask:0xf
    v_add_f32_dpp v93, v93, v93 quad_perm:[1,0,3,2] row_mask:0xf bank_mask:0xf
    v_add_f32_dpp v94, v94, v94 quad_perm:[1,0,3,2] row_mask:0xf bank_mask:0xf
    v_add_f32_dpp v95, v95, v95 quad_perm:[1,0,3,2] row_mask:0xf bank_mask:0xf
    v_add_f32_dpp v96, v96, v96 quad_perm:[1,0,3,2] row_mask:0xf bank_mask:0xf
    v_add_f32_dpp v97, v97, v97 quad_perm:[1,0,3,2] row_mask:0xf bank_mask:0xf
    v_add_f32_dpp v98, v98, v98 quad_perm:[1,0,3,2] row_mask:0xf bank_mask:0xf
    v_add_f32_dpp v99, v99, v99 quad_perm:[1,0,3,2] row_mask:0xf bank_mask:0xf
    v_add_f32_dpp v84, v84, v84 quad_perm:[2,3,0,1] row_mask:0xf bank_mask:0xf
    v_add_f32_dpp v85, v85, v85 quad_perm:[2,3,0,1] row_mask:0xf bank_mask:0xf
    v_add_f32_dpp v86, v86, v86 quad_perm:[2,3,0,1] row_mask:0xf bank_mask:0xf
    v_add_f32_dpp v87, v87, v87 quad_perm:[2,3,0,1] row_mask:0xf bank_mask:0xf
    v_add_f32_dpp v88, v88, v88 quad_perm:[2,3,0,1] row_mask:0xf bank_mask:0xf
    v_add_f32_dpp v89, v89, v89 quad_perm:[2,3,0,1] row_mask:0xf bank_mask:0xf
    v_add_f32_dpp v90, v90, v90 quad_perm:[2,3,0,1] row_mask:0xf bank_mask:0xf
    v_add_f32_dpp v91, v91, v91 quad_perm:[2,3,0,1] row_mask:0xf bank_mask:0xf
    v_add_f32_dpp v92, v92, v92 quad_perm:[2,3,0,1] row_mask:0xf bank_mask:0xf
    v_add_f32_dpp v93, v93, v93 quad_perm:[2,3,0,1] row_mask:0xf bank_mask:0xf
    v_add_f32_dpp v94, v94, v94 quad_perm:[2,3,0,1] row_mask:0xf bank_mask:0xf
    v_add_f32_dpp v95, v95, v95 quad_perm:[2,3,0,1] row_mask:0xf bank_mask:0xf
    v_add_f32_dpp v96, v96, v96 quad_perm:[2,3,0,1] row_mask:0xf bank_mask:0xf
    v_add_f32_dpp v97, v97, v97 quad_perm:[2,3,0,1] row_mask:0xf bank_mask:0xf
    v_add_f32_dpp v98, v98, v98 quad_perm:[2,3,0,1] row_mask:0xf bank_mask:0xf
    v_add_f32_dpp v99, v99, v99 quad_perm:[2,3,0,1] row_mask:0xf bank_mask:0xf
    v_add_f32_dpp v84, v84, v84 row_half_mirror row_mask:0xf bank_mask:0xf
    v_add_f32_dpp v85, v85, v85 row_half_mirror row_mask:0xf bank_mask:0xf
    v_add_f32_dpp v86, v86, v86 row_half_mirror row_mask:0xf bank_mask:0xf
    v_add_f32_dpp v87, v87, v87 row_half_mirror row_mask:0xf bank_mask:0xf
    v_add_f32_dpp v88, v88, v88 row_half_mirror row_mask:0xf bank_mask:0xf
    v_add_f32_dpp v89, v89, v89 row_half_mirror row_mask:0xf bank_mask:0xf
    v_add_f32_dpp v90, v90, v90 row_half_mirror row_mask:0xf bank_mask:0xf
    v_add_f32_dpp v91, v91, v91 row_half_mirror row_mask:0xf bank_mask:0xf
    v_add_f32_dpp v92, v92, v92 row_half_mirror row_mask:0xf bank_mask:0xf
    v_add_f32_dpp v93, v93, v93 row_half_mirror row_mask:0xf bank_mask:0xf
    v_add_f32_dpp v94, v94, v94 row_half_mirror row_mask:0xf bank_mask:0xf
    v_add_f32_dpp v95, v95, v95 row_half_mirror row_mask:0xf bank_mask:0xf
    v_add_f32_dpp v96, v96, v96 row_half_mirror row_mask:0xf bank_mask:0xf
    v_add_f32_dpp v97, v97, v97 row_half_mirror row_mask:0xf bank_mask:0xf
    v_add_f32_dpp v98, v98, v98 row_half_mirror row_mask:0xf bank_mask:0xf
    v_add_f32_dpp v99, v99, v99 row_half_mirror row_mask:0xf bank_mask:0xf
    v_add_f32_dpp v84, v84, v84 row_mirror row_mask:0xf bank_mask:0xf
    v_add_f32_dpp v85, v85, v85 row_mirror row_mask:0xf bank_mask:0xf
    v_add_f32_dpp v86, v86, v86 row_mirror row_mask:0xf bank_mask:0xf
    v_add_f32_dpp v87, v87, v87 row_mirror row_mask:0xf bank_mask:0xf
    v_add_f32_dpp v88, v88, v88 row_mirror row_mask:0xf bank_mask:0xf
    v_add_f32_dpp v89, v89, v89 row_mirror row_mask:0xf bank_mask:0xf
    v_add_f32_dpp v90, v90, v90 row_mirror row_mask:0xf bank_mask:0xf
    v_add_f32_dpp v91, v91, v91 row_mirror row_mask:0xf bank_mask:0xf
    v_add_f32_dpp v92, v92, v92 row_mirror row_mask:0xf bank_mask:0xf
    v_add_f32_dpp v93, v93, v93 row_mirror row_mask:0xf bank_mask:0xf
    v_add_f32_dpp v94, v94, v94 row_mirror row_mask:0xf bank_mask:0xf
    v_add_f32_dpp v95, v95, v95 row_mirror row_mask:0xf bank_mask:0xf
    v_add_f32_dpp v96, v96, v96 row_mirror row_mask:0xf bank_mask:0xf
    v_add_f32_dpp v97, v97, v97 row_mirror row_mask:0xf bank_mask:0xf
    v_add_f32_dpp v98, v98, v98 row_mirror row_mask:0xf bank_mask:0xf
    v_add_f32_dpp v99, v99, v99 row_mirror row_mask:0xf bank_mask:0xf
    v_add_f32_dpp v84, v84, v84 row_bcast:15 row_mask:0xa bank_mask:0xf
    v_add_f32_dpp v85, v85, v85 row_bcast:15 row_mask:0xa bank_mask:0xf
    v_add_f32_dpp v86, v86, v86 row_bcast:15 row_mask:0xa bank_mask:0xf
    v_add_f32_dpp v87, v87, v87 row_bcast:15 row_mask:0xa bank_mask:0xf
    v_add_f32_dpp v88, v88, v88 row_bcast:15 row_mask:0xa bank_mask:0xf
    v_add_f32_dpp v89, v89, v89 row_bcast:15 row_mask:0xa bank_mask:0xf
    v_add_f32_dpp v90, v90, v90 row_bcast:15 row_mask:0xa bank_mask:0xf
    v_add_f32_dpp v91, v91, v91 row_bcast:15 row_mask:0xa bank_mask:0xf
    v_add_f32_dpp v92, v92, v92 row_bcast:15 row_mask:0xa bank_mask:0xf
    v_add_f32_dpp v93, v93, v93 row_bcast:15 row_mask:0xa bank_mask:0xf
    v_add_f32_dpp v94, v94, v94 row_bcast:15 row_mask:0xa bank_mask:0xf
    v_add_f32_dpp v95, v95, v95 row_bcast:15 row_mask:0xa bank_mask:0xf
    v_add_f32_dpp v96, v96, v96 row_bcast:15 row_mask:0xa bank_mask:0xf
    v_add_f32_dpp v97, v97, v97 row_bcast:15 row_mask:0xa bank_mask:0xf
    v_add_f32_dpp v98, v98, v98 row_bcast:15 row_mask:0xa bank_mask:0xf
    v_add_f32_dpp v99, v99, v99 row_bcast:15 row_mask:0xa bank_mask:0xf
    v_add_f32_dpp v84, v84, v84 row_bcast:31 row_mask:0xc bank_mask:0xf
    v_add_f32_dpp v85, v85, v85 row_bcast:31 row_mask:0xc bank_mask:0xf
    v_add_f32_dpp v86, v86, v86 row_bcast:31 row_mask:0xc bank_mask:0xf
    v_add_f32_dpp v87, v87, v87 row_bcast:31 row_mask:0xc bank_mask:0xf
    v_add_f32_dpp v88, v88, v88 row_bcast:31 row_mask:0xc bank_mask:0xf
    v_add_f32_dpp v89, v89, v89 row_bcast:31 row_mask:0xc bank_mask:0xf
    v_add_f32_dpp v90, v90, v90 row_bcast:31 row_mask:0xc bank_mask:0xf
    v_add_f32_dpp v91, v91, v91 row_bcast:31 row_mask:0xc bank_mask:0xf
    v_add_f32_dpp v92, v92, v92 row_bcast:31 row_mask:0xc bank_mask:0xf
    v_add_f32_dpp v93, v93, v93 row_bcast:31 row_mask:0xc bank_mask:0xf
    v_add_f32_dpp v94, v94, v94 row_bcast:31 row_mask:0xc bank_mask:0xf
    v_add_f32_dpp v95, v95, v95 row_bcast:31 row_mask:0xc bank_mask:0xf
    v_add_f32_dpp v96, v96, v96 row_bcast:31 row_mask:0xc bank_mask:0xf
    v_add_f32_dpp v97, v97, v97 row_bcast:31 row_mask:0xc bank_mask:0xf
    v_add_f32_dpp v98, v98, v98 row_bcast:31 row_mask:0xc bank_mask:0xf
    v_add_f32_dpp v99, v99, v99 row_bcast:31 row_mask:0xc bank_mask:0xf
    v_mul_f32 v84, 0xbfb8aa3b, v84
    v_mul_f32 v85, 0xbfb8aa3b, v85
    v_mul_f32 v86, 0xbfb8aa3b, v86
    v_mul_f32 v87, 0xbfb8aa3b, v87
    v_mul_f32 v88, 0xbfb8aa3b, v88
    v_mul_f32 v89, 0xbfb8aa3b, v89
    v_mul_f32 v90, 0xbfb8aa3b, v90
    v_mul_f32 v91, 0xbfb8aa3b, v91
    v_mul_f32 v92, 0xbfb8aa3b, v92
    v_mul_f32 v93, 0xbfb8aa3b, v93
    v_mul_f32 v94, 0xbfb8aa3b, v94
    v_mul_f32 v95, 0xbfb8aa3b, v95
    v_mul_f32 v96, 0xbfb8aa3b, v96
    v_mul_f32 v97, 0xbfb8aa3b, v97
    v_mul_f32 v98, 0xbfb8aa3b, v98
    v_mul_f32 v99, 0xbfb8aa3b, v99
    v_exp_f32 v84, v84
    v_exp_f32 v85, v85
    v_exp_f32 v86, v86
    v_exp_f32 v87, v87
    v_exp_f32 v88, v88
    v_exp_f32 v89, v89
    v_exp_f32 v90, v90
    v_exp_f32 v91, v91
    v_exp_f32 v92, v92
    v_exp_f32 v93, v93
    v_exp_f32 v94, v94
    v_exp_f32 v95, v95
    v_exp_f32 v96, v96
    v_exp_f32 v97, v97
    v_exp_f32 v98, v98
    v_exp_f32 v99, v99
    v_add_f32 v84, 1.0, v84
    v_add_f32 v85, 1.0, v85
    v_add_f32 v86, 1.0, v86
    v_add_f32 v87, 1.0, v87
    v_add_f32 v88, 1.0, v88
    v_add_f32 v89, 1.0, v89
    v_add_f32 v90, 1.0, v90
    v_add_f32 v91, 1.0, v91
    v_add_f32 v92, 1.0, v92
    v_add_f32 v93, 1.0, v93
    v_add_f32 v94, 1.0, v94
    v_add_f32 v95, 1.0, v95
    v_add_f32 v96, 1.0, v96
    v_add_f32 v97, 1.0, v97
    v_add_f32 v98, 1.0, v98
    v_add_f32 v99, 1.0, v99
    v_rcp_f32 v84, v84
    v_rcp_f32 v85, v85
    v_rcp_f32 v86, v86
    v_rcp_f32 v87, v87
    v_rcp_f32 v88, v88
    v_rcp_f32 v89, v89
    v_rcp_f32 v90, v90
    v_rcp_f32 v91, v91
    v_rcp_f32 v92, v92
    v_rcp_f32 v93, v93
    v_rcp_f32 v94, v94
    v_rcp_f32 v95, v95
    v_rcp_f32 v96, v96
    v_rcp_f32 v97, v97
    v_rcp_f32 v98, v98
    v_rcp_f32 v99, v99
    s_mov_b32 exec_lo, 0
    s_mov_b32 exec_hi, 0x80000000
    global_store_dwordx4 v10, v[84:87], s[18:19] offset:0 sc1
    global_store_dwordx4 v10, v[88:91], s[18:19] offset:16 sc1
    global_store_dwordx4 v10, v[92:95], s[18:19] offset:32 sc1
    global_store_dwordx4 v10, v[96:99], s[18:19] offset:48 sc1
    s_mov_b64 exec, -1
    s_branch L_S1
L_LAST:
    s_endpgm
.section .rodata,"a"
.p2align 6
.amdhsa_kernel gated_mix__ssm_conv_h3__glu_gated_bilinear__prompt_kernel
  .amdhsa_next_free_vgpr 252
  .amdhsa_next_free_sgpr 64
  .amdhsa_accum_offset 252
  .amdhsa_group_segment_fixed_size 0
  .amdhsa_kernarg_size 112
  .amdhsa_user_sgpr_count 2
  .amdhsa_user_sgpr_kernarg_segment_ptr 1
  .amdhsa_system_sgpr_workgroup_id_x 1
  .amdhsa_float_denorm_mode_32 3
.end_amdhsa_kernel
```
